```python
import torch

def _softmax(x, axis=-1):
    return torch.softmax(x, dim=axis)
def _gelu(x):
    return torch.nn.functional.gelu(x, approximate="tanh")
def _silu(x):
    return torch.nn.functional.silu(x)
def _sigmoid(x):
    return torch.sigmoid(x)
def _layernorm(x, axis=-1, eps=1e-5):
    m = x.mean(dim=axis, keepdim=True)
    v = x.var(dim=axis, keepdim=True, unbiased=False)
    return (x - m) / torch.sqrt(v + eps)
def _scatter_add(tgt, idx, src, axis=0):
    return tgt.clone().index_add_(axis, idx, src)
def _segment_sum(src, seg, n):
    out = torch.zeros((n,) + src.shape[1:], dtype=src.dtype)
    return out.index_add_(0, seg, src)
def _pad(x, pw):
    flat = tuple(v for pair in reversed(pw) for v in pair)
    return torch.nn.functional.pad(x, flat)

kernel_name = 'sequential_preLN__gqa_block_cached__dense_activation_silu__decode'

def setup_inputs():

    _w = (lambda a: (lambda t: t.to(torch.bfloat16) if t.is_floating_point() else t)(torch.as_tensor(a)))
    def _A_setup():
        B, Sq, D = 2, 1, 448
        Hq, Hkv, Sk, Dh = 16, 8, 32768, 256
        assert Hq % Hkv == 0, (Hq, Hkv)
        return {
            "x": _w((lambda *s: torch.randn(*s, dtype=torch.bfloat16) * 0.1)(B, Sq, D)),
            "k_cache": _w((lambda *s: torch.randn(*s, dtype=torch.bfloat16) * 1.6)(B, Hkv, Sk, Dh)),
            "v_cache": _w((lambda *s: torch.randn(*s, dtype=torch.bfloat16) * 1.6)(B, Hkv, Sk, Dh)),
            "wq": _w((lambda *s: torch.randn(*s, dtype=torch.bfloat16) * 1.6)(D, Hq * Dh) * (D ** -0.5)),
            "wo": _w((lambda *s: torch.randn(*s, dtype=torch.bfloat16) * 1.6)(Hq * Dh, D) * ((Hq * Dh) ** -0.5)),
        }
    _A_in = _A_setup()

    def _B_setup():
        B, S, D, F = 2, 1, 448, 1792
        return {
            "x": _w((lambda *s: torch.randn(*s, dtype=torch.bfloat16) * 0.1)(B, S, D)),
            "w1": _w((lambda *s: torch.randn(*s, dtype=torch.bfloat16) * 3.2)(D, F) * (D ** -0.5)),
            "w2": _w((lambda *s: torch.randn(*s, dtype=torch.bfloat16) * 3.2)(F, D) * (F ** -0.5)),
        }
    _B_in = _B_setup()

    return {
        "A_x": _A_in["x"],
        "A_k_cache": _A_in["k_cache"],
        "A_v_cache": _A_in["v_cache"],
        "A_wq": _A_in["wq"],
        "A_wo": _A_in["wo"],
        "B_x": _B_in["x"],
        "B_w1": _B_in["w1"],
        "B_w2": _B_in["w2"],
    }

def reference(A_x, A_k_cache, A_v_cache, A_wq, A_wo, B_x, B_w1, B_w2):
    def _A_ref(x, k_cache, v_cache, wq, wo):
        B, Sq, D = x.shape
        Hq, Dh = 16, 256
        Hkv = k_cache.shape[1]
        rep = Hq // Hkv
        q = (lambda x, *d: x.permute(*d))((x @ wq).reshape(B, Sq, Hq, Dh), 0, 2, 1, 3)
        k = (lambda x, n, axis: torch.repeat_interleave(x, n, dim=axis))(k_cache, rep, axis=1)
        v = (lambda x, n, axis: torch.repeat_interleave(x, n, dim=axis))(v_cache, rep, axis=1)
        scores = torch.einsum("bhqd,bhkd->bhqk", q, k) * (Dh ** -0.5)
        p = _softmax(scores, axis=-1)
        o = torch.einsum("bhqk,bhkd->bhqd", p, v)
        return (lambda x, *d: x.permute(*d))(o, 0, 2, 1, 3).reshape(B, Sq, Hq * Dh) @ wo

    def _B_ref(x, w1, w2):
        h = torch.einsum("bsd,df->bsf", x, w1)
        h = _silu(h)
        out = torch.einsum("bsf,fd->bsd", h, w2)
        return out

    x = A_x
    h = x + _A_ref(_layernorm(x, axis=-1), A_k_cache, A_v_cache, A_wq, A_wo)
    h2 = h + _B_ref(_layernorm(h, axis=-1), B_w1, B_w2)
    return h2
```

```asm
; @launch grid=(256,1,1) block=(320,1,1) lds=163840
.amdgcn_target "amdgcn-amd-amdhsa--gfx950"
.text
.globl sequential_preLN__gqa_block_cached__dense_activation_silu__decode_kernel
.p2align 12
.p2align 8
.type sequential_preLN__gqa_block_cached__dense_activation_silu__decode_kernel,@function
sequential_preLN__gqa_block_cached__dense_activation_silu__decode_kernel:
  s_cmp_ge_u32 s2, 256
  s_cbranch_scc1 L_end
  s_load_dwordx16 s[4:19], s[0:1], 0
  s_load_dwordx4 s[20:23], s[0:1], 64
  s_load_dwordx2 s[24:25], s[0:1], 80
  v_lshrrev_b32 v1, 6, v0
  v_and_b32 v0, 63, v0
  v_readfirstlane_b32 s3, v1
  s_lshr_b32 s26, s2, 4
  s_and_b32 s27, s2, 15
  s_lshr_b32 s34, s27, 1
  s_and_b32 s34, s34, 4
  s_and_b32 s28, s27, 3
  s_add_u32 s28, s28, s34
  s_sub_u32 s28, s28, s26
  s_and_b32 s28, s28, 7
  s_add_u32 s34, s28, 4
  s_add_u32 s35, s28, 8
  s_cmp_lt_u32 s28, 4
  s_cselect_b32 s28, s28, s35
  s_bitcmp1_b32 s27, 2
  s_cselect_b32 s28, s28, s34
  s_mov_b32 s31, 0
  s_mov_b64 s[32:33], 0
  s_mov_b32 s37, 0
  s_mov_b32 s38, 1048576
  v_mov_b32 v3, 147456
  v_lshl_add_u32 v1, v0, 2, v3
  v_mov_b32 v2, 0
  s_mov_b64 exec, 6
  v_bfrev_b32 v2, -2
  s_mov_b64 exec, 0x1fff
  ds_write_b32 v1, v2
  s_mov_b64 exec, -1
  v_lshrrev_b32 v1, 5, v0
  v_mul_u32_u24 v1, 896, v1
  v_and_b32 v2, 31, v0
  v_lshl_add_u32 v132, v2, 2, v1
  s_waitcnt lgkmcnt(0)
  s_barrier
  s_cmp_eq_u32 s3, 0
  s_cbranch_scc1 L_loader
  s_load_dword s47, s[24:25], 0
  s_cmp_ge_u32 s28, 4
  s_cbranch_scc1 L_consumer
  global_load_dword v108, v132, s[4:5] offset:0
  global_load_dword v109, v132, s[4:5] offset:128
  global_load_dword v110, v132, s[4:5] offset:256
  global_load_dword v111, v132, s[4:5] offset:384
  global_load_dword v112, v132, s[4:5] offset:512
  global_load_dword v113, v132, s[4:5] offset:640
  global_load_dword v114, v132, s[4:5] offset:768
  s_branch L_qprod
L_loader:
  s_setprio 3
  v_mov_b32 v21, v3
  s_mov_b32 s62, 0
  s_mov_b32 s50, 3670016
  s_mov_b32 s51, 0x20000
  s_cmp_ge_u32 s28, 4
  s_cbranch_scc1 L_ld_noq
  v_lshrrev_b32 v1, 3, v0
  v_and_b32 v2, 7, v0
  v_and_b32 v3, 2, v1
  v_xor_b32 v2, v2, v3
  v_lshlrev_b32 v2, 4, v2
  v_mul_u32_u24 v3, 8192, v1
  v_add_u32 v17, v3, v2
  v_xor_b32 v2, 64, v2
  v_add_u32 v18, v3, v2
  s_mov_b64 s[48:49], s[10:11]
  s_and_b32 s58, s26, 7
  s_lshl_b32 s58, s58, 3
  s_lshr_b32 s34, s26, 3
  s_lshl_b32 s34, s34, 2
  s_add_u32 s58, s58, s34
  s_add_u32 s58, s58, s28
  s_lshl_b32 s58, s58, 7
  s_mov_b32 m0, 0
L_ld_q:
  s_nop 0
  buffer_load_dwordx4 v17, s[48:51], s58 offen nt lds
  s_add_u32 s58, s58, 65536
  s_add_u32 m0, m0, 1024
  s_nop 0
  buffer_load_dwordx4 v18, s[48:51], s58 offen nt lds
  s_add_u32 s58, s58, 65536
  s_add_u32 m0, m0, 1024
  s_cmp_lt_u32 m0, 57344
  s_cbranch_scc1 L_ld_q
  s_mov_b32 s31, 4
  s_mov_b32 s32, 65536
  s_mov_b32 s62, 4
  v_mov_b32 v22, 4
  s_waitcnt vmcnt(0)
  s_mov_b64 exec, 1
  ds_write_b32 v21, v22
  s_mov_b64 exec, -1
L_ld_noq:
  s_cmp_eq_u32 s2, 243
  s_cbranch_scc1 L_probe
L_ld_wo:
  v_lshrrev_b32 v1, 5, v0
  v_and_b32 v2, 31, v0
  v_lshlrev_b32 v3, 1, v1
  v_xor_b32 v3, v2, v3
  v_lshlrev_b32 v3, 4, v3
  v_lshl_or_b32 v3, v1, 9, v3
  v_xor_b32 v12, 0, v3
  v_xor_b32 v13, 64, v3
  v_xor_b32 v14, 128, v3
  v_xor_b32 v15, 192, v3
  s_mov_b64 s[44:45], s[8:9]
  s_brev_b32 s46, 8
  s_mov_b32 s47, s51
  s_lshl_b32 s57, s26, 24
  s_mov_b32 s60, s57
  s_bfe_u32 s34, s27, 0x20000
  s_lshl_b32 s34, s34, 15
  s_or_b32 s60, s60, s34
  s_bfe_u32 s34, s27, 0x20002
  s_lshl_b32 s34, s34, 20
  s_or_b32 s60, s60, s34
  s_sub_u32 s34, s28, 8
  s_lshl_b32 s39, s26, 1
  s_add_u32 s39, s39, s34
  s_cmp_lt_u32 s34, 2
  s_cselect_b32 s39, s39, 99
  s_cmp_lt_u32 s28, 4
  s_cselect_b32 s68, 2, 4
  s_cmp_lt_u32 s39, 28
  s_cselect_b32 s68, 0, s68
  s_cmp_eq_u32 s39, 30
  s_cselect_b32 s68, 0, s68
  s_cmp_lt_u32 s28, 4
  s_cselect_b32 s66, 131072, 0
  s_cmp_lt_u32 s39, 30
  s_cselect_b32 s66, 262144, s66
  s_cmp_eq_u32 s39, 30
  s_cselect_b32 s66, 524288, s66
  s_mov_b32 s56, s66
  s_cmp_lt_u32 s39, 28
  s_cbranch_scc1 L_ld_ffn
  s_or_b32 s61, s60, s56
  s_add_u32 s36, s31, s68
  s_cmp_eq_u32 s68, 0
  s_cbranch_scc1 L_ld_head_done
L_ld_pv:
  s_mov_b32 m0, s32
  s_mov_b32 s58, s61
  buffer_load_dwordx4 v12, s[44:47], s58 offen offset:0 nt lds
  buffer_load_dwordx4 v13, s[44:47], s58 offen offset:1024 nt lds
  buffer_load_dwordx4 v14, s[44:47], s58 offen offset:2048 nt lds
  buffer_load_dwordx4 v15, s[44:47], s58 offen offset:3072 nt lds
  s_waitcnt vmcnt(19)
  s_sub_u32 s34, s31, 1
  s_max_i32 s34, s34, s62
  v_mov_b32 v22, s34
  s_mov_b64 exec, 1
  ds_write_b32 v21, v22
  s_mov_b64 exec, -1
  s_add_u32 m0, s32, 4096
  s_add_u32 s58, s61, 4096
  buffer_load_dwordx4 v12, s[44:47], s58 offen offset:0 nt lds
  buffer_load_dwordx4 v13, s[44:47], s58 offen offset:1024 nt lds
  buffer_load_dwordx4 v14, s[44:47], s58 offen offset:2048 nt lds
  buffer_load_dwordx4 v15, s[44:47], s58 offen offset:3072 nt lds
  s_waitcnt vmcnt(19)
  s_add_u32 m0, s32, 8192
  s_add_u32 s58, s61, 8192
  buffer_load_dwordx4 v12, s[44:47], s58 offen offset:0 nt lds
  buffer_load_dwordx4 v13, s[44:47], s58 offen offset:1024 nt lds
  buffer_load_dwordx4 v14, s[44:47], s58 offen offset:2048 nt lds
  buffer_load_dwordx4 v15, s[44:47], s58 offen offset:3072 nt lds
  s_waitcnt vmcnt(19)
  s_add_u32 m0, s32, 12288
  s_add_u32 s58, s61, 12288
  buffer_load_dwordx4 v12, s[44:47], s58 offen offset:0 nt lds
  buffer_load_dwordx4 v13, s[44:47], s58 offen offset:1024 nt lds
  buffer_load_dwordx4 v14, s[44:47], s58 offen offset:2048 nt lds
  buffer_load_dwordx4 v15, s[44:47], s58 offen offset:3072 nt lds
  s_waitcnt vmcnt(19)
  s_add_u32 s31, s31, 1
  s_add_u32 s32, s32, 16384
  s_cmp_eq_u32 s32, 147456
  s_cselect_b32 s32, 0, s32
  s_or_b32 s56, s56, 0xff31bfff
  s_add_u32 s56, s56, 1
  s_and_b32 s56, s56, 0xce4000
  s_or_b32 s61, s60, s56
  s_cmp_lt_u32 s31, s36
  s_cbranch_scc1 L_ld_pv
L_ld_head_done:
  s_mov_b32 s64, s56
  s_mov_b32 s56, s66
  s_cmp_lt_u32 s28, 4
  s_cselect_b32 s63, 56, 58
  s_cmp_lt_u32 s39, 30
  s_cselect_b32 s63, 54, s63
  s_cmp_eq_u32 s39, 30
  s_cselect_b32 s63, 50, s63
  v_lshrrev_b32 v1, 5, v0
  v_and_b32 v2, 31, v0
  v_xor_b32 v3, v2, v1
  v_lshlrev_b32 v3, 4, v3
  v_lshl_or_b32 v3, v1, 9, v3
  v_xor_b32 v4, 0, v3
  v_xor_b32 v5, 32, v3
  v_xor_b32 v6, 64, v3
  v_xor_b32 v7, 96, v3
  v_xor_b32 v8, 128, v3
  v_xor_b32 v9, 160, v3
  v_xor_b32 v10, 192, v3
  v_xor_b32 v11, 224, v3
  s_lshl_b32 s34, s26, 8
  s_add_u32 s34, s34, 4096
  v_mov_b32 v28, s34
  v_mov_b32 v29, 1
  s_mov_b64 s[40:41], s[6:7]
  s_mov_b32 s42, 0x10000000
  s_mov_b32 s43, 0x20000
  s_or_b32 s61, s60, s56
L_ld_loop:
  s_add_u32 s34, s33, 8
  s_cmp_ge_u32 s34, s31
  s_cbranch_scc1 L_free_1
L_freepoll_2:
  ds_read_b128 v[24:27], v21 offset:16
  s_sub_u32 s38, s38, 1
  s_cbranch_scc1 L_end
  s_waitcnt lgkmcnt(0)
  v_min3_u32 v24, v24, v25, v26
  v_min_u32 v24, v24, v27
  s_nop 0
  v_readfirstlane_b32 s33, v24
  s_add_u32 s34, s33, 8
  s_cmp_ge_u32 s34, s31
  s_cbranch_scc1 L_free_1
  s_sleep 1
  s_branch L_freepoll_2
L_free_1:
  s_add_u32 s37, s37, 1
  s_add_u32 s34, s37, 1
  s_cmp_lt_u32 s34, s63
  s_cbranch_scc1 L_nocl_3
  s_cmp_eq_u32 s37, s63
  s_cbranch_scc1 L_cl1_4
  s_mov_b64 exec, 1
  global_atomic_add v30, v28, v29, s[24:25] offset:0 sc0
  s_mov_b64 exec, -1
  s_branch L_nocl_3
L_cl1_4:
  s_mov_b64 exec, 1
  global_atomic_add v31, v28, v29, s[24:25] offset:0 sc0
  s_mov_b64 exec, -1
L_nocl_3:
  s_mov_b32 m0, s32
  s_mov_b32 s58, s61
  buffer_load_dwordx4 v4, s[40:43], s58 offen offset:0 nt lds
  buffer_load_dwordx4 v5, s[40:43], s58 offen offset:1024 nt lds
  buffer_load_dwordx4 v6, s[40:43], s58 offen offset:2048 nt lds
  buffer_load_dwordx4 v7, s[40:43], s58 offen offset:3072 nt lds
  s_waitcnt vmcnt(19)
  s_sub_u32 s34, s31, 1
  s_max_i32 s34, s34, s62
  v_mov_b32 v22, s34
  s_mov_b64 exec, 1
  ds_write_b32 v21, v22
  s_mov_b64 exec, -1
  s_add_u32 m0, s32, 4096
  s_add_u32 s58, s61, 4096
  buffer_load_dwordx4 v8, s[40:43], s58 offen offset:0 nt lds
  buffer_load_dwordx4 v9, s[40:43], s58 offen offset:1024 nt lds
  buffer_load_dwordx4 v10, s[40:43], s58 offen offset:2048 nt lds
  buffer_load_dwordx4 v11, s[40:43], s58 offen offset:3072 nt lds
  s_waitcnt vmcnt(19)
  s_add_u32 m0, s32, 8192
  s_add_u32 s58, s61, 8192
  buffer_load_dwordx4 v4, s[40:43], s58 offen offset:0 nt lds
  buffer_load_dwordx4 v5, s[40:43], s58 offen offset:1024 nt lds
  buffer_load_dwordx4 v6, s[40:43], s58 offen offset:2048 nt lds
  buffer_load_dwordx4 v7, s[40:43], s58 offen offset:3072 nt lds
  s_waitcnt vmcnt(19)
  s_add_u32 m0, s32, 12288
  s_add_u32 s58, s61, 12288
  buffer_load_dwordx4 v8, s[40:43], s58 offen offset:0 nt lds
  buffer_load_dwordx4 v9, s[40:43], s58 offen offset:1024 nt lds
  buffer_load_dwordx4 v10, s[40:43], s58 offen offset:2048 nt lds
  buffer_load_dwordx4 v11, s[40:43], s58 offen offset:3072 nt lds
  s_waitcnt vmcnt(19)
  s_add_u32 s31, s31, 1
  s_add_u32 s32, s32, 16384
  s_cmp_eq_u32 s32, 147456
  s_cselect_b32 s32, 0, s32
  s_or_b32 s56, s56, 0xff31bfff
  s_add_u32 s56, s56, 1
  s_and_b32 s56, s56, 0xce4000
  s_or_b32 s61, s60, s56
  s_cmp_lt_u32 s37, s63
  s_cbranch_scc1 L_ld_loop
  s_mov_b32 s65, 0
L_ld_kdyn:
  v_readfirstlane_b32 s59, v30
  s_cmp_ge_u32 s59, 48
  s_cbranch_scc1 L_ld_kdone
  s_cmp_lt_u32 s59, 16
  s_cbranch_scc1 L_ld_shed0
  s_and_b32 s35, s59, 15
  s_lshr_b32 s56, s59, 4
  s_add_u32 s56, s56, 57
L_ld_unit0:
  s_mov_b32 s61, s57
  s_bfe_u32 s34, s35, 0x20000
  s_lshl_b32 s34, s34, 15
  s_or_b32 s61, s61, s34
  s_bfe_u32 s34, s35, 0x20002
  s_lshl_b32 s34, s34, 20
  s_or_b32 s61, s61, s34
  s_bfe_u32 s34, s56, 0x10000
  s_lshl_b32 s34, s34, 14
  s_or_b32 s61, s61, s34
  s_bfe_u32 s34, s56, 0x30001
  s_lshl_b32 s34, s34, 17
  s_or_b32 s61, s61, s34
  s_bfe_u32 s34, s56, 0x20004
  s_lshl_b32 s34, s34, 22
  s_or_b32 s61, s61, s34
  s_mov_b32 m0, s65
  v_writelane_b32 v19, s61, m0
  s_add_u32 s65, s65, 1
  s_add_u32 s34, s33, 8
  s_cmp_ge_u32 s34, s31
  s_cbranch_scc1 L_free_5
L_freepoll_6:
  ds_read_b128 v[24:27], v21 offset:16
  s_sub_u32 s38, s38, 1
  s_cbranch_scc1 L_end
  s_waitcnt lgkmcnt(0)
  v_min3_u32 v24, v24, v25, v26
  v_min_u32 v24, v24, v27
  s_nop 0
  v_readfirstlane_b32 s33, v24
  s_add_u32 s34, s33, 8
  s_cmp_ge_u32 s34, s31
  s_cbranch_scc1 L_free_5
  s_sleep 1
  s_branch L_freepoll_6
L_free_5:
  s_cmp_ge_u32 s65, 23
  s_cbranch_scc1 L_full_7
  s_mov_b64 exec, 1
  global_atomic_add v30, v28, v29, s[24:25] offset:0 sc0
  s_mov_b64 exec, -1
  s_branch L_go_8
L_full_7:
  v_mov_b32 v30, 48
L_go_8:
  s_mov_b32 m0, s32
  s_mov_b32 s58, s61
  buffer_load_dwordx4 v4, s[40:43], s58 offen offset:0 nt lds
  buffer_load_dwordx4 v5, s[40:43], s58 offen offset:1024 nt lds
  buffer_load_dwordx4 v6, s[40:43], s58 offen offset:2048 nt lds
  buffer_load_dwordx4 v7, s[40:43], s58 offen offset:3072 nt lds
  s_waitcnt vmcnt(19)
  s_sub_u32 s34, s31, 1
  s_max_i32 s34, s34, s62
  v_mov_b32 v22, s34
  s_mov_b64 exec, 1
  ds_write_b32 v21, v22
  s_mov_b64 exec, -1
  s_add_u32 m0, s32, 4096
  s_add_u32 s58, s61, 4096
  buffer_load_dwordx4 v8, s[40:43], s58 offen offset:0 nt lds
  buffer_load_dwordx4 v9, s[40:43], s58 offen offset:1024 nt lds
  buffer_load_dwordx4 v10, s[40:43], s58 offen offset:2048 nt lds
  buffer_load_dwordx4 v11, s[40:43], s58 offen offset:3072 nt lds
  s_waitcnt vmcnt(19)
  s_add_u32 m0, s32, 8192
  s_add_u32 s58, s61, 8192
  buffer_load_dwordx4 v4, s[40:43], s58 offen offset:0 nt lds
  buffer_load_dwordx4 v5, s[40:43], s58 offen offset:1024 nt lds
  buffer_load_dwordx4 v6, s[40:43], s58 offen offset:2048 nt lds
  buffer_load_dwordx4 v7, s[40:43], s58 offen offset:3072 nt lds
  s_waitcnt vmcnt(19)
  s_add_u32 m0, s32, 12288
  s_add_u32 s58, s61, 12288
  buffer_load_dwordx4 v8, s[40:43], s58 offen offset:0 nt lds
  buffer_load_dwordx4 v9, s[40:43], s58 offen offset:1024 nt lds
  buffer_load_dwordx4 v10, s[40:43], s58 offen offset:2048 nt lds
  buffer_load_dwordx4 v11, s[40:43], s58 offen offset:3072 nt lds
  s_waitcnt vmcnt(19)
  s_add_u32 s31, s31, 1
  s_add_u32 s32, s32, 16384
  s_cmp_eq_u32 s32, 147456
  s_cselect_b32 s32, 0, s32
  v_readfirstlane_b32 s59, v31
  s_cmp_ge_u32 s59, 48
  s_cbranch_scc1 L_ld_kdone
  s_cmp_lt_u32 s59, 16
  s_cbranch_scc1 L_ld_shed1
  s_and_b32 s35, s59, 15
  s_lshr_b32 s56, s59, 4
  s_add_u32 s56, s56, 57
L_ld_unit1:
  s_mov_b32 s61, s57
  s_bfe_u32 s34, s35, 0x20000
  s_lshl_b32 s34, s34, 15
  s_or_b32 s61, s61, s34
  s_bfe_u32 s34, s35, 0x20002
  s_lshl_b32 s34, s34, 20
  s_or_b32 s61, s61, s34
  s_bfe_u32 s34, s56, 0x10000
  s_lshl_b32 s34, s34, 14
  s_or_b32 s61, s61, s34
  s_bfe_u32 s34, s56, 0x30001
  s_lshl_b32 s34, s34, 17
  s_or_b32 s61, s61, s34
  s_bfe_u32 s34, s56, 0x20004
  s_lshl_b32 s34, s34, 22
  s_or_b32 s61, s61, s34
  s_mov_b32 m0, s65
  v_writelane_b32 v19, s61, m0
  s_add_u32 s65, s65, 1
  s_add_u32 s34, s33, 8
  s_cmp_ge_u32 s34, s31
  s_cbranch_scc1 L_free_9
L_freepoll_10:
  ds_read_b128 v[24:27], v21 offset:16
  s_sub_u32 s38, s38, 1
  s_cbranch_scc1 L_end
  s_waitcnt lgkmcnt(0)
  v_min3_u32 v24, v24, v25, v26
  v_min_u32 v24, v24, v27
  s_nop 0
  v_readfirstlane_b32 s33, v24
  s_add_u32 s34, s33, 8
  s_cmp_ge_u32 s34, s31
  s_cbranch_scc1 L_free_9
  s_sleep 1
  s_branch L_freepoll_10
L_free_9:
  s_cmp_ge_u32 s65, 23
  s_cbranch_scc1 L_full_11
  s_mov_b64 exec, 1
  global_atomic_add v31, v28, v29, s[24:25] offset:0 sc0
  s_mov_b64 exec, -1
  s_branch L_go_12
L_full_11:
  v_mov_b32 v31, 48
L_go_12:
  s_mov_b32 m0, s32
  s_mov_b32 s58, s61
  buffer_load_dwordx4 v4, s[40:43], s58 offen offset:0 nt lds
  buffer_load_dwordx4 v5, s[40:43], s58 offen offset:1024 nt lds
  buffer_load_dwordx4 v6, s[40:43], s58 offen offset:2048 nt lds
  buffer_load_dwordx4 v7, s[40:43], s58 offen offset:3072 nt lds
  s_waitcnt vmcnt(19)
  s_sub_u32 s34, s31, 1
  s_max_i32 s34, s34, s62
  v_mov_b32 v22, s34
  s_mov_b64 exec, 1
  ds_write_b32 v21, v22
  s_mov_b64 exec, -1
  s_add_u32 m0, s32, 4096
  s_add_u32 s58, s61, 4096
  buffer_load_dwordx4 v8, s[40:43], s58 offen offset:0 nt lds
  buffer_load_dwordx4 v9, s[40:43], s58 offen offset:1024 nt lds
  buffer_load_dwordx4 v10, s[40:43], s58 offen offset:2048 nt lds
  buffer_load_dwordx4 v11, s[40:43], s58 offen offset:3072 nt lds
  s_waitcnt vmcnt(19)
  s_add_u32 m0, s32, 8192
  s_add_u32 s58, s61, 8192
  buffer_load_dwordx4 v4, s[40:43], s58 offen offset:0 nt lds
  buffer_load_dwordx4 v5, s[40:43], s58 offen offset:1024 nt lds
  buffer_load_dwordx4 v6, s[40:43], s58 offen offset:2048 nt lds
  buffer_load_dwordx4 v7, s[40:43], s58 offen offset:3072 nt lds
  s_waitcnt vmcnt(19)
  s_add_u32 m0, s32, 12288
  s_add_u32 s58, s61, 12288
  buffer_load_dwordx4 v8, s[40:43], s58 offen offset:0 nt lds
  buffer_load_dwordx4 v9, s[40:43], s58 offen offset:1024 nt lds
  buffer_load_dwordx4 v10, s[40:43], s58 offen offset:2048 nt lds
  buffer_load_dwordx4 v11, s[40:43], s58 offen offset:3072 nt lds
  s_waitcnt vmcnt(19)
  s_add_u32 s31, s31, 1
  s_add_u32 s32, s32, 16384
  s_cmp_eq_u32 s32, 147456
  s_cselect_b32 s32, 0, s32
  s_branch L_ld_kdyn
L_ld_kdone:
  v_mov_b32 v22, s31
  s_mov_b64 exec, 1
  ds_write_b32 v21, v22 offset:8
  s_mov_b64 exec, -1
  s_add_u32 s65, s65, s63
  s_mov_b32 s37, s68
  s_mov_b32 s56, s64
  s_or_b32 s61, s60, s56
L_ld_vloop:
  s_add_u32 s34, s33, 8
  s_cmp_ge_u32 s34, s31
  s_cbranch_scc1 L_free_13
L_freepoll_14:
  ds_read_b128 v[24:27], v21 offset:16
  s_sub_u32 s38, s38, 1
  s_cbranch_scc1 L_end
  s_waitcnt lgkmcnt(0)
  v_min3_u32 v24, v24, v25, v26
  v_min_u32 v24, v24, v27
  s_nop 0
  v_readfirstlane_b32 s33, v24
  s_add_u32 s34, s33, 8
  s_cmp_ge_u32 s34, s31
  s_cbranch_scc1 L_free_13
  s_sleep 1
  s_branch L_freepoll_14
L_free_13:
  s_sub_u32 s34, s37, s63
  s_cbranch_scc1 L_ld_vown
  v_readlane_b32 s61, v19, s34
L_ld_vown:
  s_add_u32 s37, s37, 1
  s_add_u32 s34, s37, 1
  s_cmp_lt_u32 s34, s65
  s_cbranch_scc1 L_nocl_15
  s_cmp_eq_u32 s37, s65
  s_cbranch_scc1 L_cl1_16
  s_mov_b64 exec, 1
  global_atomic_add v30, v28, v29, s[24:25] offset:128 sc0
  s_mov_b64 exec, -1
  s_branch L_nocl_15
L_cl1_16:
  s_mov_b64 exec, 1
  global_atomic_add v31, v28, v29, s[24:25] offset:128 sc0
  s_mov_b64 exec, -1
L_nocl_15:
  s_mov_b32 m0, s32
  s_mov_b32 s58, s61
  buffer_load_dwordx4 v12, s[44:47], s58 offen offset:0 nt lds
  buffer_load_dwordx4 v13, s[44:47], s58 offen offset:1024 nt lds
  buffer_load_dwordx4 v14, s[44:47], s58 offen offset:2048 nt lds
  buffer_load_dwordx4 v15, s[44:47], s58 offen offset:3072 nt lds
  s_waitcnt vmcnt(19)
  s_sub_u32 s34, s31, 1
  s_max_i32 s34, s34, s62
  v_mov_b32 v22, s34
  s_mov_b64 exec, 1
  ds_write_b32 v21, v22
  s_mov_b64 exec, -1
  s_add_u32 m0, s32, 4096
  s_add_u32 s58, s61, 4096
  buffer_load_dwordx4 v12, s[44:47], s58 offen offset:0 nt lds
  buffer_load_dwordx4 v13, s[44:47], s58 offen offset:1024 nt lds
  buffer_load_dwordx4 v14, s[44:47], s58 offen offset:2048 nt lds
  buffer_load_dwordx4 v15, s[44:47], s58 offen offset:3072 nt lds
  s_waitcnt vmcnt(19)
  s_add_u32 m0, s32, 8192
  s_add_u32 s58, s61, 8192
  buffer_load_dwordx4 v12, s[44:47], s58 offen offset:0 nt lds
  buffer_load_dwordx4 v13, s[44:47], s58 offen offset:1024 nt lds
  buffer_load_dwordx4 v14, s[44:47], s58 offen offset:2048 nt lds
  buffer_load_dwordx4 v15, s[44:47], s58 offen offset:3072 nt lds
  s_waitcnt vmcnt(19)
  s_add_u32 m0, s32, 12288
  s_add_u32 s58, s61, 12288
  buffer_load_dwordx4 v12, s[44:47], s58 offen offset:0 nt lds
  buffer_load_dwordx4 v13, s[44:47], s58 offen offset:1024 nt lds
  buffer_load_dwordx4 v14, s[44:47], s58 offen offset:2048 nt lds
  buffer_load_dwordx4 v15, s[44:47], s58 offen offset:3072 nt lds
  s_waitcnt vmcnt(19)
  s_add_u32 s31, s31, 1
  s_add_u32 s32, s32, 16384
  s_cmp_eq_u32 s32, 147456
  s_cselect_b32 s32, 0, s32
  s_or_b32 s56, s56, 0xff31bfff
  s_add_u32 s56, s56, 1
  s_and_b32 s56, s56, 0xce4000
  s_or_b32 s61, s60, s56
  s_cmp_lt_u32 s37, s65
  s_cbranch_scc1 L_ld_vloop
L_ld_dyn:
  v_readfirstlane_b32 s59, v30
  s_cmp_ge_u32 s59, 128
  s_cbranch_scc1 L_ld_dyn_done
  s_bfe_u32 s35, s59, 0x40001
  s_lshr_b32 s56, s59, 5
  s_add_u32 s56, s56, 60
  s_and_b32 s61, s59, 1
  s_lshl_b32 s61, s61, 12
  s_or_b32 s61, s61, s57
  s_bfe_u32 s34, s35, 0x20000
  s_lshl_b32 s34, s34, 15
  s_or_b32 s61, s61, s34
  s_bfe_u32 s34, s35, 0x20002
  s_lshl_b32 s34, s34, 20
  s_or_b32 s61, s61, s34
  s_bfe_u32 s34, s56, 0x10000
  s_lshl_b32 s34, s34, 14
  s_or_b32 s61, s61, s34
  s_bfe_u32 s34, s56, 0x30001
  s_lshl_b32 s34, s34, 17
  s_or_b32 s61, s61, s34
  s_bfe_u32 s34, s56, 0x20004
  s_lshl_b32 s34, s34, 22
  s_or_b32 s61, s61, s34
  s_add_u32 s34, s33, 8
  s_cmp_ge_u32 s34, s31
  s_cbranch_scc1 L_free_17
L_freepoll_18:
  ds_read_b128 v[24:27], v21 offset:16
  s_sub_u32 s38, s38, 1
  s_cbranch_scc1 L_end
  s_waitcnt lgkmcnt(0)
  v_min3_u32 v24, v24, v25, v26
  v_min_u32 v24, v24, v27
  s_nop 0
  v_readfirstlane_b32 s33, v24
  s_add_u32 s34, s33, 8
  s_cmp_ge_u32 s34, s31
  s_cbranch_scc1 L_free_17
  s_sleep 1
  s_branch L_freepoll_18
L_free_17:
  s_mov_b64 exec, 1
  global_atomic_add v30, v28, v29, s[24:25] offset:128 sc0
  s_mov_b64 exec, -1
  s_mov_b32 m0, s32
  s_mov_b32 s58, s61
  buffer_load_dwordx4 v4, s[40:43], s58 offen offset:0 nt lds
  buffer_load_dwordx4 v5, s[40:43], s58 offen offset:1024 nt lds
  buffer_load_dwordx4 v6, s[40:43], s58 offen offset:2048 nt lds
  buffer_load_dwordx4 v7, s[40:43], s58 offen offset:3072 nt lds
  s_waitcnt vmcnt(19)
  s_sub_u32 s34, s31, 1
  s_max_i32 s34, s34, s62
  v_mov_b32 v22, s34
  s_mov_b64 exec, 1
  ds_write_b32 v21, v22
  s_mov_b64 exec, -1
  s_add_u32 m0, s32, 4096
  s_add_u32 s58, s61, 8192
  buffer_load_dwordx4 v8, s[40:43], s58 offen offset:0 nt lds
  buffer_load_dwordx4 v9, s[40:43], s58 offen offset:1024 nt lds
  buffer_load_dwordx4 v10, s[40:43], s58 offen offset:2048 nt lds
  buffer_load_dwordx4 v11, s[40:43], s58 offen offset:3072 nt lds
  s_waitcnt vmcnt(19)
  s_add_u32 m0, s32, 8192
  s_mov_b32 s58, s61
  buffer_load_dwordx4 v12, s[44:47], s58 offen offset:0 nt lds
  buffer_load_dwordx4 v13, s[44:47], s58 offen offset:1024 nt lds
  buffer_load_dwordx4 v14, s[44:47], s58 offen offset:2048 nt lds
  buffer_load_dwordx4 v15, s[44:47], s58 offen offset:3072 nt lds
  s_waitcnt vmcnt(19)
  s_add_u32 m0, s32, 12288
  s_add_u32 s58, s61, 8192
  buffer_load_dwordx4 v12, s[44:47], s58 offen offset:0 nt lds
  buffer_load_dwordx4 v13, s[44:47], s58 offen offset:1024 nt lds
  buffer_load_dwordx4 v14, s[44:47], s58 offen offset:2048 nt lds
  buffer_load_dwordx4 v15, s[44:47], s58 offen offset:3072 nt lds
  s_waitcnt vmcnt(19)
  s_add_u32 s31, s31, 1
  s_add_u32 s32, s32, 16384
  s_cmp_eq_u32 s32, 147456
  s_cselect_b32 s32, 0, s32
  v_readfirstlane_b32 s59, v31
  s_cmp_ge_u32 s59, 128
  s_cbranch_scc1 L_ld_dyn_done
  s_bfe_u32 s35, s59, 0x40001
  s_lshr_b32 s56, s59, 5
  s_add_u32 s56, s56, 60
  s_and_b32 s61, s59, 1
  s_lshl_b32 s61, s61, 12
  s_or_b32 s61, s61, s57
  s_bfe_u32 s34, s35, 0x20000
  s_lshl_b32 s34, s34, 15
  s_or_b32 s61, s61, s34
  s_bfe_u32 s34, s35, 0x20002
  s_lshl_b32 s34, s34, 20
  s_or_b32 s61, s61, s34
  s_bfe_u32 s34, s56, 0x10000
  s_lshl_b32 s34, s34, 14
  s_or_b32 s61, s61, s34
  s_bfe_u32 s34, s56, 0x30001
  s_lshl_b32 s34, s34, 17
  s_or_b32 s61, s61, s34
  s_bfe_u32 s34, s56, 0x20004
  s_lshl_b32 s34, s34, 22
  s_or_b32 s61, s61, s34
  s_add_u32 s34, s33, 8
  s_cmp_ge_u32 s34, s31
  s_cbranch_scc1 L_free_19
L_freepoll_20:
  ds_read_b128 v[24:27], v21 offset:16
  s_sub_u32 s38, s38, 1
  s_cbranch_scc1 L_end
  s_waitcnt lgkmcnt(0)
  v_min3_u32 v24, v24, v25, v26
  v_min_u32 v24, v24, v27
  s_nop 0
  v_readfirstlane_b32 s33, v24
  s_add_u32 s34, s33, 8
  s_cmp_ge_u32 s34, s31
  s_cbranch_scc1 L_free_19
  s_sleep 1
  s_branch L_freepoll_20
L_free_19:
  s_mov_b64 exec, 1
  global_atomic_add v31, v28, v29, s[24:25] offset:128 sc0
  s_mov_b64 exec, -1
  s_mov_b32 m0, s32
  s_mov_b32 s58, s61
  buffer_load_dwordx4 v4, s[40:43], s58 offen offset:0 nt lds
  buffer_load_dwordx4 v5, s[40:43], s58 offen offset:1024 nt lds
  buffer_load_dwordx4 v6, s[40:43], s58 offen offset:2048 nt lds
  buffer_load_dwordx4 v7, s[40:43], s58 offen offset:3072 nt lds
  s_waitcnt vmcnt(19)
  s_sub_u32 s34, s31, 1
  s_max_i32 s34, s34, s62
  v_mov_b32 v22, s34
  s_mov_b64 exec, 1
  ds_write_b32 v21, v22
  s_mov_b64 exec, -1
  s_add_u32 m0, s32, 4096
  s_add_u32 s58, s61, 8192
  buffer_load_dwordx4 v8, s[40:43], s58 offen offset:0 nt lds
  buffer_load_dwordx4 v9, s[40:43], s58 offen offset:1024 nt lds
  buffer_load_dwordx4 v10, s[40:43], s58 offen offset:2048 nt lds
  buffer_load_dwordx4 v11, s[40:43], s58 offen offset:3072 nt lds
  s_waitcnt vmcnt(19)
  s_add_u32 m0, s32, 8192
  s_mov_b32 s58, s61
  buffer_load_dwordx4 v12, s[44:47], s58 offen offset:0 nt lds
  buffer_load_dwordx4 v13, s[44:47], s58 offen offset:1024 nt lds
  buffer_load_dwordx4 v14, s[44:47], s58 offen offset:2048 nt lds
  buffer_load_dwordx4 v15, s[44:47], s58 offen offset:3072 nt lds
  s_waitcnt vmcnt(19)
  s_add_u32 m0, s32, 12288
  s_add_u32 s58, s61, 8192
  buffer_load_dwordx4 v12, s[44:47], s58 offen offset:0 nt lds
  buffer_load_dwordx4 v13, s[44:47], s58 offen offset:1024 nt lds
  buffer_load_dwordx4 v14, s[44:47], s58 offen offset:2048 nt lds
  buffer_load_dwordx4 v15, s[44:47], s58 offen offset:3072 nt lds
  s_waitcnt vmcnt(19)
  s_add_u32 s31, s31, 1
  s_add_u32 s32, s32, 16384
  s_cmp_eq_u32 s32, 147456
  s_cselect_b32 s32, 0, s32
  s_branch L_ld_dyn
L_ld_dyn_done:
  v_mov_b32 v22, s31
  s_mov_b64 exec, 1
  ds_write_b32 v21, v22 offset:4
  s_mov_b64 exec, -1
  s_mov_b64 s[48:49], s[12:13]
  s_mov_b32 s50, 3670016
  s_and_b32 s61, s2, 127
  s_mul_i32 s61, s61, 28672
  v_lshlrev_b32 v16, 4, v0
  s_add_u32 s34, s33, 7
  s_cmp_ge_u32 s34, s31
  s_cbranch_scc1 L_free_21
L_freepoll_22:
  ds_read_b128 v[24:27], v21 offset:16
  s_sub_u32 s38, s38, 1
  s_cbranch_scc1 L_end
  s_waitcnt lgkmcnt(0)
  v_min3_u32 v24, v24, v25, v26
  v_min_u32 v24, v24, v27
  s_nop 0
  v_readfirstlane_b32 s33, v24
  s_add_u32 s34, s33, 7
  s_cmp_ge_u32 s34, s31
  s_cbranch_scc1 L_free_21
  s_sleep 1
  s_branch L_freepoll_22
L_free_21:
  s_mov_b32 m0, s32
  s_add_u32 s58, s61, 0
  buffer_load_dwordx4 v16, s[48:51], s58 offen offset:0 lds
  buffer_load_dwordx4 v16, s[48:51], s58 offen offset:1024 lds
  s_waitcnt vmcnt(18)
  s_sub_u32 s34, s31, 1
  s_max_i32 s34, s34, s62
  v_mov_b32 v22, s34
  s_mov_b64 exec, 1
  ds_write_b32 v21, v22
  s_mov_b64 exec, -1
  buffer_load_dwordx4 v16, s[48:51], s58 offen offset:2048 lds
  buffer_load_dwordx4 v16, s[48:51], s58 offen offset:3072 lds
  s_add_u32 m0, s32, 4096
  s_add_u32 s58, s61, 4096
  s_waitcnt vmcnt(4)
  s_sub_u32 s34, s31, 0
  s_max_i32 s34, s34, s62
  v_mov_b32 v22, s34
  s_mov_b64 exec, 1
  ds_write_b32 v21, v22
  s_mov_b64 exec, -1
  buffer_load_dwordx4 v16, s[48:51], s58 offen offset:0 lds
  buffer_load_dwordx4 v16, s[48:51], s58 offen offset:1024 lds
  buffer_load_dwordx4 v16, s[48:51], s58 offen offset:2048 lds
  buffer_load_dwordx4 v16, s[48:51], s58 offen offset:3072 lds
  s_add_u32 m0, s32, 8192
  s_add_u32 s58, s61, 8192
  buffer_load_dwordx4 v16, s[48:51], s58 offen offset:0 lds
  buffer_load_dwordx4 v16, s[48:51], s58 offen offset:1024 lds
  buffer_load_dwordx4 v16, s[48:51], s58 offen offset:2048 lds
  buffer_load_dwordx4 v16, s[48:51], s58 offen offset:3072 lds
  s_add_u32 m0, s32, 12288
  s_add_u32 s58, s61, 12288
  buffer_load_dwordx4 v16, s[48:51], s58 offen offset:0 lds
  buffer_load_dwordx4 v16, s[48:51], s58 offen offset:1024 lds
  s_add_u32 s31, s31, 1
  s_add_u32 s32, s32, 16384
  s_cmp_eq_u32 s32, 147456
  s_cselect_b32 s32, 0, s32
  s_mov_b32 m0, s32
  s_add_u32 s58, s61, 14336
  buffer_load_dwordx4 v16, s[48:51], s58 offen offset:0 lds
  buffer_load_dwordx4 v16, s[48:51], s58 offen offset:1024 lds
  buffer_load_dwordx4 v16, s[48:51], s58 offen offset:2048 lds
  buffer_load_dwordx4 v16, s[48:51], s58 offen offset:3072 lds
  s_add_u32 m0, s32, 4096
  s_add_u32 s58, s61, 18432
  buffer_load_dwordx4 v16, s[48:51], s58 offen offset:0 lds
  buffer_load_dwordx4 v16, s[48:51], s58 offen offset:1024 lds
  buffer_load_dwordx4 v16, s[48:51], s58 offen offset:2048 lds
  buffer_load_dwordx4 v16, s[48:51], s58 offen offset:3072 lds
  s_add_u32 m0, s32, 8192
  s_add_u32 s58, s61, 22528
  buffer_load_dwordx4 v16, s[48:51], s58 offen offset:0 lds
  buffer_load_dwordx4 v16, s[48:51], s58 offen offset:1024 lds
  buffer_load_dwordx4 v16, s[48:51], s58 offen offset:2048 lds
  buffer_load_dwordx4 v16, s[48:51], s58 offen offset:3072 lds
  s_add_u32 m0, s32, 12288
  s_add_u32 s58, s61, 26624
  buffer_load_dwordx4 v16, s[48:51], s58 offen offset:0 lds
  buffer_load_dwordx4 v16, s[48:51], s58 offen offset:1024 lds
  s_add_u32 s31, s31, 1
  s_add_u32 s32, s32, 16384
  s_cmp_eq_u32 s32, 147456
  s_cselect_b32 s32, 0, s32
  s_waitcnt vmcnt(14)
  s_sub_u32 s34, s31, 1
  s_max_i32 s34, s34, s62
  v_mov_b32 v22, s34
  s_mov_b64 exec, 1
  ds_write_b32 v21, v22
  s_mov_b64 exec, -1
  s_waitcnt vmcnt(0)
  s_sub_u32 s34, s31, 0
  s_max_i32 s34, s34, s62
  v_mov_b32 v22, s34
  s_mov_b64 exec, 1
  ds_write_b32 v21, v22
  s_mov_b64 exec, -1
  s_waitcnt lgkmcnt(0)
  s_endpgm
L_ld_shed0:
  s_lshr_b32 s34, s59, 2
  s_and_b32 s35, s59, 3
  s_add_u32 s35, s35, 0
  s_add_u32 s36, s59, 0
  s_cmp_eq_u32 s26, 15
  s_cselect_b32 s34, 0, s34
  s_cselect_b32 s35, s36, s35
  s_add_u32 s34, s34, 4
  s_bfe_u32 s36, s59, 0x20001
  s_and_b32 s56, s59, 1
  s_add_u32 s56, s56, 0
  s_cmp_lt_u32 s59, 8
  s_cselect_b32 s34, s34, s36
  s_cselect_b32 s56, s35, s56
  s_cselect_b32 s36, 0, 4
  s_add_u32 s34, s34, s26
  s_and_b32 s35, s34, 3
  s_or_b32 s35, s35, s36
  s_bfe_u32 s34, s34, 0x10002
  s_lshl_b32 s34, s34, 3
  s_or_b32 s35, s35, s34
  s_branch L_ld_unit0
L_ld_shed1:
  s_lshr_b32 s34, s59, 2
  s_and_b32 s35, s59, 3
  s_add_u32 s35, s35, 0
  s_add_u32 s36, s59, 0
  s_cmp_eq_u32 s26, 15
  s_cselect_b32 s34, 0, s34
  s_cselect_b32 s35, s36, s35
  s_add_u32 s34, s34, 4
  s_bfe_u32 s36, s59, 0x20001
  s_and_b32 s56, s59, 1
  s_add_u32 s56, s56, 0
  s_cmp_lt_u32 s59, 8
  s_cselect_b32 s34, s34, s36
  s_cselect_b32 s56, s35, s56
  s_cselect_b32 s36, 0, 4
  s_add_u32 s34, s34, s26
  s_and_b32 s35, s34, 3
  s_or_b32 s35, s35, s36
  s_bfe_u32 s34, s34, 0x10002
  s_lshl_b32 s34, s34, 3
  s_or_b32 s35, s35, s34
  s_branch L_ld_unit1
.p2align 12
L_qprod:
  s_sub_u32 s40, s3, 1
  s_lshr_b32 s29, s26, 3
  s_and_b32 s30, s26, 7
  v_and_b32 v1, 15, v0
  v_lshrrev_b32 v2, 4, v0
  s_lshl_b32 s34, s40, 2
  s_add_u32 s34, s34, 147472
  v_mov_b32 v4, s34
  s_mov_b32 s42, 0xffff0000
  s_mov_b32 s43, s42
  s_or_b32 s34, s28, s40
  s_cmp_lg_u32 s34, 0
  s_cbranch_scc1 L_noinit
  s_lshl_b32 s34, s26, 8
  s_add_u32 s34, s34, 4096
  v_mov_b32 v6, s34
  v_mov_b32 v7, 0
  s_mov_b64 exec, 1
  global_store_dword v6, v7, s[24:25] sc1
  global_store_dword v6, v7, s[24:25] offset:128 sc1
  s_mov_b64 exec, -1
L_noinit:
  v_add_u32 v132, 149504, v132
  v_and_b32 v133, 1, v0
  v_mul_u32_u24 v133, 896, v133
  v_lshl_add_u32 v133, v2, 4, v133
  v_add_u32 v133, 149504, v133
  v_lshrrev_b32 v5, 3, v1
  v_and_b32 v6, 1, v2
  v_lshl_or_b32 v5, v6, 1, v5
  v_xor_b32 v5, s40, v5
  v_lshlrev_b32 v5, 5, v5
  v_and_b32 v6, 3, v1
  v_lshl_or_b32 v5, v6, 3, v5
  v_lshrrev_b32 v6, 2, v1
  v_lshl_or_b32 v5, v6, 7, v5
  v_lshl_or_b32 v134, v2, 10, v5
  s_lshl_b32 s34, s29, 2
  s_add_u32 s34, s34, s28
  s_lshl_b32 s34, s34, 2
  s_add_u32 s34, s34, s40
  s_lshl_b32 s34, s34, 6
  s_lshl_b32 s35, s30, 11
  s_add_u32 s34, s34, s35
  s_add_u32 s34, s34, 32768
  v_lshlrev_b32 v135, 2, v1
  v_lshl_add_u32 v135, v2, 14, v135
  v_add_u32 v135, s34, v135
  s_branch L_pad_q
L_ret_q:
  s_waitcnt vmcnt(0) lgkmcnt(0)
  v_lshlrev_b32 v116, 16, v108
  v_and_b32 v117, 0xffff0000, v108
  v_lshlrev_b32 v118, 16, v109
  v_and_b32 v119, 0xffff0000, v109
  v_lshlrev_b32 v120, 16, v110
  v_and_b32 v121, 0xffff0000, v110
  v_lshlrev_b32 v122, 16, v111
  v_and_b32 v123, 0xffff0000, v111
  v_lshlrev_b32 v124, 16, v112
  v_and_b32 v125, 0xffff0000, v112
  v_lshlrev_b32 v126, 16, v113
  v_and_b32 v127, 0xffff0000, v113
  v_lshlrev_b32 v128, 16, v114
  v_and_b32 v129, 0xffff0000, v114
  v_pk_add_f32 v[250:251], v[116:117], v[118:119]
  v_pk_add_f32 v[252:253], v[120:121], v[122:123]
  v_pk_add_f32 v[250:251], v[250:251], v[124:125]
  v_pk_add_f32 v[252:253], v[252:253], v[126:127]
  v_pk_add_f32 v[250:251], v[250:251], v[128:129]
  v_pk_add_f32 v[250:251], v[250:251], v[252:253]
  v_add_f32 v5, v250, v251
  s_nop 1
  v_add_f32_dpp v5, v5, v5 row_ror:8 row_mask:0xf bank_mask:0xf
  s_nop 1
  v_add_f32_dpp v5, v5, v5 row_ror:4 row_mask:0xf bank_mask:0xf
  s_nop 1
  v_add_f32_dpp v5, v5, v5 row_ror:2 row_mask:0xf bank_mask:0xf
  s_nop 1
  v_add_f32_dpp v5, v5, v5 row_ror:1 row_mask:0xf bank_mask:0xf
  v_mov_b32 v6, v5
  s_nop 1
  v_permlane16_swap_b32 v5, v6
  v_add_f32 v5, v5, v6
  v_mul_f32 v248, 0x3b124925, v5
  v_pk_add_f32 v[252:253], v[116:117], v[248:249] op_sel_hi:[1,0] neg_lo:[0,1] neg_hi:[0,1]
  v_pk_mul_f32 v[250:251], v[252:253], v[252:253]
  v_pk_add_f32 v[252:253], v[118:119], v[248:249] op_sel_hi:[1,0] neg_lo:[0,1] neg_hi:[0,1]
  v_pk_fma_f32 v[250:251], v[252:253], v[252:253], v[250:251]
  v_pk_add_f32 v[252:253], v[120:121], v[248:249] op_sel_hi:[1,0] neg_lo:[0,1] neg_hi:[0,1]
  v_pk_fma_f32 v[250:251], v[252:253], v[252:253], v[250:251]
  v_pk_add_f32 v[252:253], v[122:123], v[248:249] op_sel_hi:[1,0] neg_lo:[0,1] neg_hi:[0,1]
  v_pk_fma_f32 v[250:251], v[252:253], v[252:253], v[250:251]
  v_pk_add_f32 v[252:253], v[124:125], v[248:249] op_sel_hi:[1,0] neg_lo:[0,1] neg_hi:[0,1]
  v_pk_fma_f32 v[250:251], v[252:253], v[252:253], v[250:251]
  v_pk_add_f32 v[252:253], v[126:127], v[248:249] op_sel_hi:[1,0] neg_lo:[0,1] neg_hi:[0,1]
  v_pk_fma_f32 v[250:251], v[252:253], v[252:253], v[250:251]
  v_pk_add_f32 v[252:253], v[128:129], v[248:249] op_sel_hi:[1,0] neg_lo:[0,1] neg_hi:[0,1]
  v_pk_fma_f32 v[250:251], v[252:253], v[252:253], v[250:251]
  v_add_f32 v5, v250, v251
  v_cvt_pk_bf16_f32 v248, v248, v248
  v_and_b32 v248, 0xffff0000, v248
  v_pk_add_f32 v[116:117], v[116:117], v[248:249] op_sel_hi:[1,0] neg_lo:[0,1] neg_hi:[0,1]
  v_pk_add_f32 v[118:119], v[118:119], v[248:249] op_sel_hi:[1,0] neg_lo:[0,1] neg_hi:[0,1]
  v_add_f32_dpp v5, v5, v5 row_ror:8 row_mask:0xf bank_mask:0xf
  v_pk_add_f32 v[120:121], v[120:121], v[248:249] op_sel_hi:[1,0] neg_lo:[0,1] neg_hi:[0,1]
  v_pk_add_f32 v[122:123], v[122:123], v[248:249] op_sel_hi:[1,0] neg_lo:[0,1] neg_hi:[0,1]
  v_add_f32_dpp v5, v5, v5 row_ror:4 row_mask:0xf bank_mask:0xf
  v_pk_add_f32 v[124:125], v[124:125], v[248:249] op_sel_hi:[1,0] neg_lo:[0,1] neg_hi:[0,1]
  v_pk_add_f32 v[126:127], v[126:127], v[248:249] op_sel_hi:[1,0] neg_lo:[0,1] neg_hi:[0,1]
  v_add_f32_dpp v5, v5, v5 row_ror:2 row_mask:0xf bank_mask:0xf
  v_pk_add_f32 v[128:129], v[128:129], v[248:249] op_sel_hi:[1,0] neg_lo:[0,1] neg_hi:[0,1]
  v_cvt_pk_bf16_f32 v108, v116, v117
  v_add_f32_dpp v5, v5, v5 row_ror:1 row_mask:0xf bank_mask:0xf
  v_cvt_pk_bf16_f32 v109, v118, v119
  v_cvt_pk_bf16_f32 v110, v120, v121
  v_mov_b32 v6, v5
  v_cvt_pk_bf16_f32 v111, v122, v123
  v_cvt_pk_bf16_f32 v112, v124, v125
  v_permlane16_swap_b32 v5, v6
  v_cvt_pk_bf16_f32 v113, v126, v127
  v_cvt_pk_bf16_f32 v114, v128, v129
  v_add_f32 v5, v5, v6
  v_lshlrev_b32 v116, 16, v108
  v_and_b32 v117, 0xffff0000, v108
  v_mul_f32 v5, 0x3b124925, v5
  v_lshlrev_b32 v118, 16, v109
  v_and_b32 v119, 0xffff0000, v109
  v_cvt_pk_bf16_f32 v5, v5, v5
  v_lshlrev_b32 v120, 16, v110
  v_and_b32 v121, 0xffff0000, v110
  v_and_b32 v5, 0xffff0000, v5
  v_lshlrev_b32 v122, 16, v111
  v_and_b32 v123, 0xffff0000, v111
  v_add_f32 v5, 0x3727c5ac, v5
  v_lshlrev_b32 v124, 16, v112
  v_and_b32 v125, 0xffff0000, v112
  v_cvt_pk_bf16_f32 v5, v5, v5
  v_lshlrev_b32 v126, 16, v113
  v_and_b32 v127, 0xffff0000, v113
  v_and_b32 v5, 0xffff0000, v5
  v_lshlrev_b32 v128, 16, v114
  v_and_b32 v129, 0xffff0000, v114
  v_sqrt_f32 v5, v5
  s_nop 0
  v_cvt_pk_bf16_f32 v5, v5, v5
  v_and_b32 v5, 0xffff0000, v5
  v_rcp_f32 v250, v5
  s_branch L_padskip_23
L_pad_q:
  s_branch L_ret_q
L_padskip_23:
  v_pk_mul_f32 v[116:117], v[116:117], v[250:251] op_sel_hi:[1,0]
  v_pk_mul_f32 v[118:119], v[118:119], v[250:251] op_sel_hi:[1,0]
  v_pk_mul_f32 v[120:121], v[120:121], v[250:251] op_sel_hi:[1,0]
  v_pk_mul_f32 v[122:123], v[122:123], v[250:251] op_sel_hi:[1,0]
  v_pk_mul_f32 v[124:125], v[124:125], v[250:251] op_sel_hi:[1,0]
  v_pk_mul_f32 v[126:127], v[126:127], v[250:251] op_sel_hi:[1,0]
  v_pk_mul_f32 v[128:129], v[128:129], v[250:251] op_sel_hi:[1,0]
  v_cvt_pk_bf16_f32 v108, v116, v117
  ds_write_b32 v132, v108 offset:0
  v_cvt_pk_bf16_f32 v109, v118, v119
  ds_write_b32 v132, v109 offset:128
  v_cvt_pk_bf16_f32 v110, v120, v121
  ds_write_b32 v132, v110 offset:256
  v_cvt_pk_bf16_f32 v111, v122, v123
  ds_write_b32 v132, v111 offset:384
  v_cvt_pk_bf16_f32 v112, v124, v125
  ds_write_b32 v132, v112 offset:512
  v_cvt_pk_bf16_f32 v113, v126, v127
  ds_write_b32 v132, v113 offset:640
  v_cvt_pk_bf16_f32 v114, v128, v129
  ds_write_b32 v132, v114 offset:768
  s_mul_i32 s41, s47, 0x9e3779b1
  s_add_u32 s41, s41, 0x7f4a7c15
  v_mov_b32 v249, s41
  s_waitcnt lgkmcnt(0)
  ds_read_b128 v[192:195], v133 offset:0
  ds_read_b128 v[196:199], v133 offset:64
  ds_read_b128 v[200:203], v133 offset:128
  ds_read_b128 v[204:207], v133 offset:192
  ds_read_b128 v[208:211], v133 offset:256
  ds_read_b128 v[212:215], v133 offset:320
  ds_read_b128 v[216:219], v133 offset:384
  ds_read_b128 v[220:223], v133 offset:448
  ds_read_b128 v[224:227], v133 offset:512
  ds_read_b128 v[228:231], v133 offset:576
  ds_read_b128 v[232:235], v133 offset:640
  ds_read_b128 v[236:239], v133 offset:704
  ds_read_b128 v[240:243], v133 offset:768
  ds_read_b128 v[244:247], v133 offset:832
  s_mov_b32 s31, 3
  s_cmp_gt_u32 s33, s31
  s_cbranch_scc1 L_have_24
L_poll_25:
  ds_read_b128 v[20:23], v3
  s_sub_u32 s38, s38, 1
  s_cbranch_scc1 L_end
  s_waitcnt lgkmcnt(0)
  v_readfirstlane_b32 s33, v20
  v_readfirstlane_b32 s49, v21
  v_readfirstlane_b32 s69, v22
  s_cmp_gt_u32 s33, s31
  s_cbranch_scc1 L_have_24
  s_sleep 1
  s_branch L_poll_25
L_have_24:
  ds_read_b64_tr_b16 v[136:137], v134 offset:0
  ds_read_b64_tr_b16 v[138:139], v134 offset:512
  ds_read_b64_tr_b16 v[140:141], v134 offset:4096
  ds_read_b64_tr_b16 v[142:143], v134 offset:4608
  ds_read_b64_tr_b16 v[144:145], v134 offset:8192
  ds_read_b64_tr_b16 v[146:147], v134 offset:8704
  ds_read_b64_tr_b16 v[148:149], v134 offset:12288
  ds_read_b64_tr_b16 v[150:151], v134 offset:12800
  s_waitcnt lgkmcnt(0)
  v_mfma_f32_16x16x32_bf16 v[24:27], v[192:195], v[136:139], 0
  v_mfma_f32_16x16x32_bf16 v[24:27], v[196:199], v[140:143], v[24:27]
  v_mfma_f32_16x16x32_bf16 v[24:27], v[200:203], v[144:147], v[24:27]
  v_mfma_f32_16x16x32_bf16 v[24:27], v[204:207], v[148:151], v[24:27]
  ds_read_b64_tr_b16 v[152:153], v134 offset:16384
  ds_read_b64_tr_b16 v[154:155], v134 offset:16896
  ds_read_b64_tr_b16 v[156:157], v134 offset:20480
  ds_read_b64_tr_b16 v[158:159], v134 offset:20992
  ds_read_b64_tr_b16 v[160:161], v134 offset:24576
  ds_read_b64_tr_b16 v[162:163], v134 offset:25088
  ds_read_b64_tr_b16 v[164:165], v134 offset:28672
  ds_read_b64_tr_b16 v[166:167], v134 offset:29184
  s_waitcnt lgkmcnt(0)
  v_mfma_f32_16x16x32_bf16 v[24:27], v[208:211], v[152:155], v[24:27]
  v_mfma_f32_16x16x32_bf16 v[24:27], v[212:215], v[156:159], v[24:27]
  v_mfma_f32_16x16x32_bf16 v[24:27], v[216:219], v[160:163], v[24:27]
  v_mfma_f32_16x16x32_bf16 v[24:27], v[220:223], v[164:167], v[24:27]
  ds_read_b64_tr_b16 v[168:169], v134 offset:32768
  ds_read_b64_tr_b16 v[170:171], v134 offset:33280
  ds_read_b64_tr_b16 v[172:173], v134 offset:36864
  ds_read_b64_tr_b16 v[174:175], v134 offset:37376
  ds_read_b64_tr_b16 v[176:177], v134 offset:40960
  ds_read_b64_tr_b16 v[178:179], v134 offset:41472
  ds_read_b64_tr_b16 v[180:181], v134 offset:45056
  ds_read_b64_tr_b16 v[182:183], v134 offset:45568
  s_waitcnt lgkmcnt(0)
  v_mfma_f32_16x16x32_bf16 v[24:27], v[224:227], v[168:171], v[24:27]
  v_mfma_f32_16x16x32_bf16 v[24:27], v[228:231], v[172:175], v[24:27]
  v_mfma_f32_16x16x32_bf16 v[24:27], v[232:235], v[176:179], v[24:27]
  v_mfma_f32_16x16x32_bf16 v[24:27], v[236:239], v[180:183], v[24:27]
  ds_read_b64_tr_b16 v[184:185], v134 offset:49152
  ds_read_b64_tr_b16 v[186:187], v134 offset:49664
  ds_read_b64_tr_b16 v[188:189], v134 offset:53248
  ds_read_b64_tr_b16 v[190:191], v134 offset:53760
  s_waitcnt lgkmcnt(0)
  v_mfma_f32_16x16x32_bf16 v[24:27], v[240:243], v[184:187], v[24:27]
  v_mfma_f32_16x16x32_bf16 v[24:27], v[244:247], v[188:191], v[24:27]
  s_mov_b32 s32, 49152
  s_add_u32 s31, s31, 1
  s_add_u32 s32, s32, 16384
  s_cmp_eq_u32 s32, 147456
  s_cselect_b32 s32, 0, s32
  v_mov_b32 v5, s31
  s_mov_b64 exec, 1
  ds_write_b32 v4, v5
  s_mov_b64 exec, -1
  v_cndmask_b32 v5, v24, v25, s[42:43]
  s_nop 1
  v_mov_b32_dpp v6, v5 quad_perm:[1,0,3,2] row_mask:0xf bank_mask:0xf
  v_cvt_pk_bf16_f32 v248, v5, v6
  s_mov_b64 exec, 0x55555555
  global_store_dwordx2 v135, v[248:249], s[24:25] sc1
  s_mov_b64 exec, -1
L_consumer:
  s_sub_u32 s40, s3, 1
  s_lshr_b32 s29, s26, 3
  s_and_b32 s30, s26, 7
  v_and_b32 v1, 15, v0
  v_lshrrev_b32 v2, 4, v0
  s_lshl_b32 s34, s40, 2
  s_add_u32 s34, s34, 147472
  v_mov_b32 v4, s34
  s_mov_b32 s42, 0xffff0000
  s_mov_b32 s43, s42
  s_sub_u32 s34, s28, 8
  s_lshl_b32 s39, s26, 1
  s_add_u32 s39, s39, s34
  s_cmp_lt_u32 s34, 2
  s_cselect_b32 s39, s39, 99
  s_cmp_lt_u32 s28, 4
  s_cselect_b32 s68, 2, 4
  s_cmp_lt_u32 s39, 28
  s_cselect_b32 s68, 0, s68
  s_cmp_eq_u32 s39, 30
  s_cselect_b32 s68, 0, s68
  s_mov_b32 s44, 0
  s_mov_b32 s45, -1
  s_mov_b32 s46, 0x3db8aa3b
  s_mov_b32 s66, -1
  s_mov_b32 s67, 0
  s_mov_b32 s49, 0x7fffffff
  s_mov_b32 s69, 0x7fffffff
  s_mov_b32 s33, 0
  s_mov_b32 s64, 0xcccccccc
  s_mov_b32 s65, 0xcccccccc
  s_sub_u32 s34, s28, 4
  s_lshl_b32 s48, s26, 2
  s_add_u32 s48, s48, s34
  s_cmp_lt_u32 s34, 4
  s_cselect_b32 s48, s48, 99
  s_cbranch_scc0 L_nox
  s_bfe_u32 s34, s48, 0x20003
  s_mul_i32 s58, s34, 224
  s_bfe_u32 s59, s48, 0x20001
  s_lshl_b32 s34, s59, 6
  s_add_u32 s58, s58, s34
  s_and_b32 s34, s48, 1
  s_lshl_b32 s34, s34, 4
  s_add_u32 s58, s58, s34
  s_bfe_u32 s34, s48, 0x10005
  s_mul_i32 s34, s34, 896
  s_add_u32 s58, s58, s34
  v_and_b32 v5, 6, v0
  v_lshl_add_u32 v5, v5, 1, s58
  global_load_dword v254, v5, s[4:5]
  v_mov_b32 v255, 0
  s_cmp_eq_u32 s59, 3
  s_cbranch_scc1 L_nox
  global_load_dword v255, v5, s[4:5] offset:32
L_nox:
  v_xor_b32 v5, v2, v1
  v_lshlrev_b32 v5, 4, v5
  v_lshl_or_b32 v5, v1, 9, v5
  v_xor_b32 v12, 0, v5
  v_xor_b32 v13, 64, v5
  v_xor_b32 v14, 128, v5
  v_xor_b32 v15, 192, v5
  v_lshrrev_b32 v5, 2, v1
  v_lshl_add_u32 v5, v2, 2, v5
  v_and_b32 v6, 7, v5
  s_lshl_b32 s34, s40, 2
  v_xor_b32 v6, s34, v6
  v_lshlrev_b32 v6, 5, v6
  v_lshl_or_b32 v5, v5, 9, v6
  v_and_b32 v6, 3, v1
  v_lshl_or_b32 v5, v6, 3, v5
  v_xor_b32 v16, 0, v5
  v_xor_b32 v17, 32, v5
  v_xor_b32 v18, 64, v5
  v_xor_b32 v19, 96, v5
  v_mov_b32 v8, 0xff800000
  v_mov_b32 v9, v8
  v_mov_b32 v10, 0
  v_mov_b32 v36, 0
  v_mov_b32 v37, 0
  v_mov_b32 v38, 0
  v_mov_b32 v39, 0
  v_mov_b32 v40, 0
  v_mov_b32 v41, 0
  v_mov_b32 v42, 0
  v_mov_b32 v43, 0
  v_mov_b32 v44, 0
  v_mov_b32 v45, 0
  v_mov_b32 v46, 0
  v_mov_b32 v47, 0
  v_mov_b32 v48, 0
  v_mov_b32 v49, 0
  v_mov_b32 v50, 0
  v_mov_b32 v51, 0
  s_cmp_lt_u32 s39, 28
  s_cbranch_scc1 L_ffn_w
  s_cmp_le_u32 s68, 0
  s_cbranch_scc1 L_ffn_w_done
  s_cmp_gt_u32 s33, s31
  s_cbranch_scc1 L_have_26
L_poll_27:
  ds_read_b128 v[20:23], v3
  s_sub_u32 s38, s38, 1
  s_cbranch_scc1 L_end
  s_waitcnt lgkmcnt(0)
  v_readfirstlane_b32 s33, v20
  v_readfirstlane_b32 s49, v21
  v_readfirstlane_b32 s69, v22
  s_cmp_gt_u32 s33, s31
  s_cbranch_scc1 L_have_26
  s_sleep 1
  s_branch L_poll_27
L_have_26:
  v_add_u32 v20, s32, v16
  v_add_u32 v21, s32, v17
  v_add_u32 v22, s32, v18
  v_add_u32 v23, s32, v19
  ds_read_b64_tr_b16 v[136:137], v20 offset:0
  ds_read_b64_tr_b16 v[138:139], v20 offset:8192
  ds_read_b64_tr_b16 v[140:141], v21 offset:0
  ds_read_b64_tr_b16 v[142:143], v21 offset:8192
  ds_read_b64_tr_b16 v[144:145], v22 offset:0
  ds_read_b64_tr_b16 v[146:147], v22 offset:8192
  ds_read_b64_tr_b16 v[148:149], v23 offset:0
  ds_read_b64_tr_b16 v[150:151], v23 offset:8192
  s_waitcnt lgkmcnt(0)
  s_add_u32 s31, s31, 1
  s_add_u32 s32, s32, 16384
  s_cmp_eq_u32 s32, 147456
  s_cselect_b32 s32, 0, s32
  v_mov_b32 v5, s31
  s_mov_b64 exec, 1
  ds_write_b32 v4, v5
  s_mov_b64 exec, -1
  s_cmp_le_u32 s68, 1
  s_cbranch_scc1 L_ffn_w_done
  s_cmp_gt_u32 s33, s31
  s_cbranch_scc1 L_have_28
L_poll_29:
  ds_read_b128 v[20:23], v3
  s_sub_u32 s38, s38, 1
  s_cbranch_scc1 L_end
  s_waitcnt lgkmcnt(0)
  v_readfirstlane_b32 s33, v20
  v_readfirstlane_b32 s49, v21
  v_readfirstlane_b32 s69, v22
  s_cmp_gt_u32 s33, s31
  s_cbranch_scc1 L_have_28
  s_sleep 1
  s_branch L_poll_29
L_have_28:
  v_add_u32 v20, s32, v16
  v_add_u32 v21, s32, v17
  v_add_u32 v22, s32, v18
  v_add_u32 v23, s32, v19
  ds_read_b64_tr_b16 v[152:153], v20 offset:0
  ds_read_b64_tr_b16 v[154:155], v20 offset:8192
  ds_read_b64_tr_b16 v[156:157], v21 offset:0
  ds_read_b64_tr_b16 v[158:159], v21 offset:8192
  ds_read_b64_tr_b16 v[160:161], v22 offset:0
  ds_read_b64_tr_b16 v[162:163], v22 offset:8192
  ds_read_b64_tr_b16 v[164:165], v23 offset:0
  ds_read_b64_tr_b16 v[166:167], v23 offset:8192
  s_waitcnt lgkmcnt(0)
  s_add_u32 s31, s31, 1
  s_add_u32 s32, s32, 16384
  s_cmp_eq_u32 s32, 147456
  s_cselect_b32 s32, 0, s32
  v_mov_b32 v5, s31
  s_mov_b64 exec, 1
  ds_write_b32 v4, v5
  s_mov_b64 exec, -1
  s_cmp_le_u32 s68, 2
  s_cbranch_scc1 L_ffn_w_done
  s_cmp_gt_u32 s33, s31
  s_cbranch_scc1 L_have_30
L_poll_31:
  ds_read_b128 v[20:23], v3
  s_sub_u32 s38, s38, 1
  s_cbranch_scc1 L_end
  s_waitcnt lgkmcnt(0)
  v_readfirstlane_b32 s33, v20
  v_readfirstlane_b32 s49, v21
  v_readfirstlane_b32 s69, v22
  s_cmp_gt_u32 s33, s31
  s_cbranch_scc1 L_have_30
  s_sleep 1
  s_branch L_poll_31
L_have_30:
  v_add_u32 v20, s32, v16
  v_add_u32 v21, s32, v17
  v_add_u32 v22, s32, v18
  v_add_u32 v23, s32, v19
  ds_read_b64_tr_b16 v[168:169], v20 offset:0
  ds_read_b64_tr_b16 v[170:171], v20 offset:8192
  ds_read_b64_tr_b16 v[172:173], v21 offset:0
  ds_read_b64_tr_b16 v[174:175], v21 offset:8192
  ds_read_b64_tr_b16 v[176:177], v22 offset:0
  ds_read_b64_tr_b16 v[178:179], v22 offset:8192
  ds_read_b64_tr_b16 v[180:181], v23 offset:0
  ds_read_b64_tr_b16 v[182:183], v23 offset:8192
  s_waitcnt lgkmcnt(0)
  s_add_u32 s31, s31, 1
  s_add_u32 s32, s32, 16384
  s_cmp_eq_u32 s32, 147456
  s_cselect_b32 s32, 0, s32
  v_mov_b32 v5, s31
  s_mov_b64 exec, 1
  ds_write_b32 v4, v5
  s_mov_b64 exec, -1
  s_cmp_le_u32 s68, 3
  s_cbranch_scc1 L_ffn_w_done
  s_cmp_gt_u32 s33, s31
  s_cbranch_scc1 L_have_32
L_poll_33:
  ds_read_b128 v[20:23], v3
  s_sub_u32 s38, s38, 1
  s_cbranch_scc1 L_end
  s_waitcnt lgkmcnt(0)
  v_readfirstlane_b32 s33, v20
  v_readfirstlane_b32 s49, v21
  v_readfirstlane_b32 s69, v22
  s_cmp_gt_u32 s33, s31
  s_cbranch_scc1 L_have_32
  s_sleep 1
  s_branch L_poll_33
L_have_32:
  v_add_u32 v20, s32, v16
  v_add_u32 v21, s32, v17
  v_add_u32 v22, s32, v18
  v_add_u32 v23, s32, v19
  ds_read_b64_tr_b16 v[184:185], v20 offset:0
  ds_read_b64_tr_b16 v[186:187], v20 offset:8192
  ds_read_b64_tr_b16 v[188:189], v21 offset:0
  ds_read_b64_tr_b16 v[190:191], v21 offset:8192
  ds_read_b64_tr_b16 v[192:193], v22 offset:0
  ds_read_b64_tr_b16 v[194:195], v22 offset:8192
  ds_read_b64_tr_b16 v[196:197], v23 offset:0
  ds_read_b64_tr_b16 v[198:199], v23 offset:8192
  s_waitcnt lgkmcnt(0)
  s_add_u32 s31, s31, 1
  s_add_u32 s32, s32, 16384
  s_cmp_eq_u32 s32, 147456
  s_cselect_b32 s32, 0, s32
  v_mov_b32 v5, s31
  s_mov_b64 exec, 1
  ds_write_b32 v4, v5
  s_mov_b64 exec, -1
L_ffn_w_done:
  s_waitcnt lgkmcnt(0)
  s_mul_i32 s41, s47, 0x9e3779b1
  s_add_u32 s41, s41, 0x7f4a7c15
  s_cmp_lg_u32 s40, 0
  s_cbranch_scc1 L_q_flag
  s_add_u32 s31, s31, 1
  s_cmp_gt_u32 s33, s31
  s_cbranch_scc1 L_have_34
L_poll_35:
  ds_read_b128 v[20:23], v3
  s_sub_u32 s38, s38, 1
  s_cbranch_scc1 L_end
  s_waitcnt lgkmcnt(0)
  v_readfirstlane_b32 s33, v20
  v_readfirstlane_b32 s49, v21
  v_readfirstlane_b32 s69, v22
  s_cmp_gt_u32 s33, s31
  s_cbranch_scc1 L_have_34
  s_sleep 1
  s_branch L_poll_35
L_have_34:
  s_sub_u32 s31, s31, 1
  s_lshl_b32 s34, s26, 11
  s_add_u32 s34, s34, 32768
  v_lshl_add_u32 v7, v0, 4, s34
  s_mov_b64 s[50:51], -1
  s_mov_b64 s[52:53], -1
L_gpoll_36:
  s_mov_b64 exec, s[50:51]
  s_cbranch_execz L_sk_38
  global_load_dwordx4 v[84:87], v7, s[24:25] sc1
L_sk_38:
  s_mov_b64 exec, s[52:53]
  s_cbranch_execz L_sk_39
  global_load_dwordx4 v[88:91], v7, s[24:25] offset:1024 sc1
L_sk_39:
  s_mov_b64 exec, -1
  s_sub_u32 s38, s38, 1
  s_cbranch_scc1 L_end
  s_waitcnt vmcnt(0)
  v_cmp_ne_u32 s[50:51], s41, v85
  v_cmp_ne_u32 vcc, s41, v87
  s_or_b64 s[50:51], s[50:51], vcc
  v_cmp_ne_u32 s[52:53], s41, v89
  v_cmp_ne_u32 vcc, s41, v91
  s_or_b64 s[52:53], s[52:53], vcc
  s_or_b64 vcc, s[50:51], s[52:53]
  s_cbranch_scc1 L_gpoll_36
  v_lshlrev_b32 v5, 3, v0
  v_add_u32 v5, 148480, v5
  v_mov_b32 v6, 1
  ds_write2_b32 v5, v84, v86 offset0:0 offset1:1
  ds_write2_b32 v5, v88, v90 offset0:128 offset1:129
  s_mov_b64 exec, 1
  ds_write_b32 v3, v6 offset:32
  s_mov_b64 exec, -1
L_q_flag:
  ds_read_b32 v5, v3 offset:32
  s_sub_u32 s38, s38, 1
  s_cbranch_scc1 L_end
  s_waitcnt lgkmcnt(0)
  v_readfirstlane_b32 s34, v5
  s_cmp_eq_u32 s34, 1
  s_cbranch_scc1 L_q_have
  s_sleep 1
  s_branch L_q_flag
L_q_have:
  v_and_b32 v6, 1, v0
  v_lshlrev_b32 v6, 9, v6
  v_lshl_add_u32 v6, v2, 4, v6
  v_add_u32 v6, 148480, v6
  ds_read_b128 v[52:55], v6 offset:0
  ds_read_b128 v[56:59], v6 offset:64
  ds_read_b128 v[60:63], v6 offset:128
  ds_read_b128 v[64:67], v6 offset:192
  ds_read_b128 v[68:71], v6 offset:256
  ds_read_b128 v[72:75], v6 offset:320
  ds_read_b128 v[76:79], v6 offset:384
  ds_read_b128 v[80:83], v6 offset:448
  s_waitcnt lgkmcnt(0)
  s_mov_b32 s101, s31
  s_add_u32 s31, s31, s40
  s_lshl_b32 s34, s40, 14
  s_add_u32 s32, s32, s34
  s_sub_u32 s34, s32, 147456
  s_cselect_b32 s32, s32, s34
  v_and_b32 v107, 1, v0
  v_lshlrev_b32 v107, 6, v107
  v_lshl_add_u32 v107, v2, 4, v107
  v_add_u32 v107, 151552, v107
  s_lshl_b32 s34, s40, 7
  v_add_u32 v248, s34, v107
L_kloop:
  s_cmp_ge_u32 s31, s69
  s_cbranch_scc1 L_kdone
  s_cmp_gt_u32 s33, s31
  s_cbranch_scc1 L_have_40
L_poll_41:
  ds_read_b128 v[20:23], v3
  s_sub_u32 s38, s38, 1
  s_cbranch_scc1 L_end
  s_waitcnt lgkmcnt(0)
  v_readfirstlane_b32 s33, v20
  v_readfirstlane_b32 s49, v21
  v_readfirstlane_b32 s69, v22
  s_cmp_ge_u32 s31, s69
  s_cbranch_scc1 L_kdone
  s_cmp_gt_u32 s33, s31
  s_cbranch_scc1 L_have_40
  s_sleep 1
  s_branch L_poll_41
L_have_40:
  v_add_u32 v20, s32, v12
  v_add_u32 v21, s32, v13
  v_add_u32 v22, s32, v14
  v_add_u32 v23, s32, v15
  ds_read_b128 v[84:87], v20 offset:0
  ds_read_b128 v[88:91], v20 offset:8192
  ds_read_b128 v[92:95], v21 offset:0
  ds_read_b128 v[96:99], v21 offset:8192
  ds_read_b128 v[100:103], v22 offset:0
  s_waitcnt lgkmcnt(4)
  v_mfma_f32_16x16x32_bf16 v[24:27], v[84:87], v[52:55], 0
  ds_read_b128 v[84:87], v22 offset:8192
  s_waitcnt lgkmcnt(4)
  v_mfma_f32_16x16x32_bf16 v[28:31], v[88:91], v[52:55], 0
  ds_read_b128 v[88:91], v23 offset:0
  s_waitcnt lgkmcnt(4)
  v_mfma_f32_16x16x32_bf16 v[24:27], v[92:95], v[56:59], v[24:27]
  ds_read_b128 v[92:95], v23 offset:8192
  s_waitcnt lgkmcnt(4)
  v_mfma_f32_16x16x32_bf16 v[28:31], v[96:99], v[56:59], v[28:31]
  ds_read_b128 v[96:99], v20 offset:256
  s_waitcnt lgkmcnt(4)
  v_mfma_f32_16x16x32_bf16 v[24:27], v[100:103], v[60:63], v[24:27]
  ds_read_b128 v[100:103], v20 offset:8448
  s_waitcnt lgkmcnt(4)
  v_mfma_f32_16x16x32_bf16 v[28:31], v[84:87], v[60:63], v[28:31]
  ds_read_b128 v[84:87], v21 offset:256
  s_waitcnt lgkmcnt(4)
  v_mfma_f32_16x16x32_bf16 v[24:27], v[88:91], v[64:67], v[24:27]
  ds_read_b128 v[88:91], v21 offset:8448
  s_waitcnt lgkmcnt(4)
  v_mfma_f32_16x16x32_bf16 v[28:31], v[92:95], v[64:67], v[28:31]
  ds_read_b128 v[92:95], v22 offset:256
  s_waitcnt lgkmcnt(4)
  v_mfma_f32_16x16x32_bf16 v[24:27], v[96:99], v[68:71], v[24:27]
  ds_read_b128 v[96:99], v22 offset:8448
  s_waitcnt lgkmcnt(4)
  v_mfma_f32_16x16x32_bf16 v[28:31], v[100:103], v[68:71], v[28:31]
  ds_read_b128 v[100:103], v23 offset:256
  s_waitcnt lgkmcnt(4)
  v_mfma_f32_16x16x32_bf16 v[24:27], v[84:87], v[72:75], v[24:27]
  ds_read_b128 v[84:87], v23 offset:8448
  s_waitcnt lgkmcnt(4)
  v_mfma_f32_16x16x32_bf16 v[28:31], v[88:91], v[72:75], v[28:31]
  s_waitcnt lgkmcnt(3)
  v_mfma_f32_16x16x32_bf16 v[24:27], v[92:95], v[76:79], v[24:27]
  s_waitcnt lgkmcnt(2)
  v_mfma_f32_16x16x32_bf16 v[28:31], v[96:99], v[76:79], v[28:31]
  s_waitcnt lgkmcnt(1)
  v_mfma_f32_16x16x32_bf16 v[24:27], v[100:103], v[80:83], v[24:27]
  s_waitcnt lgkmcnt(0)
  v_mfma_f32_16x16x32_bf16 v[28:31], v[84:87], v[80:83], v[28:31]
  s_add_u32 s31, s31, 4
  s_add_u32 s32, s32, 65536
  s_sub_u32 s34, s32, 147456
  s_cselect_b32 s32, s32, s34
  s_nop 1
  v_cvt_pk_bf16_f32 v32, v24, v25
  v_cvt_pk_bf16_f32 v33, v26, v27
  v_cvt_pk_bf16_f32 v34, v28, v29
  v_cvt_pk_bf16_f32 v35, v30, v31
  v_max3_f32 v8, v8, v24, v25
  v_max3_f32 v8, v8, v26, v27
  v_max3_f32 v8, v8, v28, v29
  v_max3_f32 v8, v8, v30, v31
  s_mov_b32 exec_lo, 0x30003
  s_mov_b32 exec_hi, 0x30003
  ds_write_b128 v248, v[32:35]
  s_mov_b64 exec, -1
  v_add_u32 v248, 512, v248
  v_mov_b32 v5, s31
  s_mov_b64 exec, 1
  ds_write_b32 v4, v5
  s_mov_b64 exec, -1
  s_branch L_kloop
L_kdone:
  s_mov_b32 s31, s69
  s_sub_u32 s63, s69, s101
  v_mov_b32 v5, v8
  s_nop 1
  v_permlane16_swap_b32 v8, v5
  v_max_f32 v8, v8, v5
  v_mov_b32 v5, v8
  s_nop 1
  v_permlane32_swap_b32 v8, v5
  v_max_f32 v8, v8, v5
  s_lshl_b32 s34, s40, 3
  s_add_u32 s34, s34, 147520
  v_lshl_add_u32 v6, v0, 2, s34
  s_mov_b64 exec, 3
  ds_write_b32 v6, v8
  s_mov_b64 exec, -1
  v_mov_b32 v5, s31
  s_mov_b64 exec, 1
  ds_write_b32 v4, v5
  ds_write_b32 v4, v5 offset:20
  s_mov_b64 exec, -1
  s_mul_hi_u32 s34, s31, 477218589
  s_mul_i32 s34, s34, 9
  s_sub_u32 s32, s31, s34
  s_lshl_b32 s32, s32, 14
  v_and_b32 v6, 1, v0
  v_lshlrev_b32 v6, 2, v6
  v_add_u32 v6, 147520, v6
L_ksync:
  ds_read2_b32 v[20:21], v3 offset0:9 offset1:10
  ds_read2_b32 v[22:23], v3 offset0:11 offset1:12
  ds_read2_b32 v[24:25], v6 offset0:0 offset1:2
  ds_read2_b32 v[26:27], v6 offset0:4 offset1:6
  s_sub_u32 s38, s38, 1
  s_cbranch_scc1 L_end
  s_waitcnt lgkmcnt(0)
  v_min3_u32 v20, v20, v21, v22
  v_min_u32 v20, v20, v23
  s_nop 0
  v_readfirstlane_b32 s34, v20
  s_cmp_lt_u32 s34, s69
  s_cbranch_scc1 L_ksync
  v_max3_f32 v8, v24, v25, v26
  v_max_f32 v8, v8, v27
  v_cvt_pk_bf16_f32 v8, v8, v8
  v_and_b32 v8, 0xffff0000, v8
  v_mul_f32 v9, s46, v8
L_loop:
  ds_read_b128 v[32:35], v107
  v_add_u32 v107, 128, v107
  s_waitcnt lgkmcnt(0)
  v_lshlrev_b32 v24, 16, v32
  v_and_b32 v25, 0xffff0000, v32
  v_lshlrev_b32 v26, 16, v33
  v_and_b32 v27, 0xffff0000, v33
  v_lshlrev_b32 v28, 16, v34
  v_and_b32 v29, 0xffff0000, v34
  v_lshlrev_b32 v30, 16, v35
  v_and_b32 v31, 0xffff0000, v35
  v_fma_f32 v24, v24, s46, -v9
  v_fma_f32 v25, v25, s46, -v9
  v_fma_f32 v26, v26, s46, -v9
  v_fma_f32 v27, v27, s46, -v9
  v_fma_f32 v28, v28, s46, -v9
  v_fma_f32 v29, v29, s46, -v9
  v_fma_f32 v30, v30, s46, -v9
  v_fma_f32 v31, v31, s46, -v9
  v_exp_f32 v24, v24
  v_exp_f32 v25, v25
  v_exp_f32 v26, v26
  v_exp_f32 v27, v27
  v_exp_f32 v28, v28
  v_exp_f32 v29, v29
  v_exp_f32 v30, v30
  v_exp_f32 v31, v31
  v_cvt_pk_bf16_f32 v32, v24, v25
  v_cvt_pk_bf16_f32 v33, v26, v27
  v_cvt_pk_bf16_f32 v34, v28, v29
  v_cvt_pk_bf16_f32 v35, v30, v31
  v_lshlrev_b32 v100, 16, v32
  v_and_b32 v101, 0xffff0000, v32
  v_pk_add_f32 v[100:101], v[24:25], v[100:101] neg_lo:[0,1] neg_hi:[0,1]
  v_cvt_pk_bf16_f32 v100, v100, v101
  v_cndmask_b32 v32, v32, v100, s[64:65]
  v_lshlrev_b32 v102, 16, v33
  v_and_b32 v103, 0xffff0000, v33
  v_pk_add_f32 v[102:103], v[26:27], v[102:103] neg_lo:[0,1] neg_hi:[0,1]
  v_cvt_pk_bf16_f32 v102, v102, v103
  v_cndmask_b32 v33, v33, v102, s[64:65]
  v_lshlrev_b32 v100, 16, v34
  v_and_b32 v101, 0xffff0000, v34
  v_pk_add_f32 v[100:101], v[28:29], v[100:101] neg_lo:[0,1] neg_hi:[0,1]
  v_cvt_pk_bf16_f32 v100, v100, v101
  v_cndmask_b32 v34, v34, v100, s[64:65]
  v_lshlrev_b32 v102, 16, v35
  v_and_b32 v103, 0xffff0000, v35
  v_pk_add_f32 v[102:103], v[30:31], v[102:103] neg_lo:[0,1] neg_hi:[0,1]
  v_cvt_pk_bf16_f32 v102, v102, v103
  v_cndmask_b32 v35, v35, v102, s[64:65]
  v_add_f32 v5, v24, v25
  v_add_f32 v11, v26, v27
  v_add_f32 v28, v28, v29
  v_add_f32 v30, v30, v31
  v_add_f32 v5, v5, v28
  v_add_f32 v11, v11, v30
  v_add_f32 v10, v10, v5
  v_add_f32 v10, v10, v11
  s_cmp_lt_u32 s37, s68
  s_cbranch_scc1 L_pv_park
  s_cmp_gt_u32 s33, s31
  s_cbranch_scc1 L_have_42
L_poll_43:
  ds_read_b128 v[20:23], v3
  s_sub_u32 s38, s38, 1
  s_cbranch_scc1 L_end
  s_waitcnt lgkmcnt(0)
  v_readfirstlane_b32 s33, v20
  v_readfirstlane_b32 s49, v21
  v_readfirstlane_b32 s69, v22
  s_cmp_gt_u32 s33, s31
  s_cbranch_scc1 L_have_42
  s_sleep 1
  s_branch L_poll_43
L_have_42:
  v_add_u32 v20, s32, v16
  v_add_u32 v21, s32, v17
  v_add_u32 v22, s32, v18
  v_add_u32 v23, s32, v19
  ds_read_b64_tr_b16 v[84:85], v20 offset:0
  ds_read_b64_tr_b16 v[86:87], v20 offset:8192
  ds_read_b64_tr_b16 v[88:89], v21 offset:0
  ds_read_b64_tr_b16 v[90:91], v21 offset:8192
  ds_read_b64_tr_b16 v[92:93], v22 offset:0
  ds_read_b64_tr_b16 v[94:95], v22 offset:8192
  ds_read_b64_tr_b16 v[96:97], v23 offset:0
  ds_read_b64_tr_b16 v[98:99], v23 offset:8192
  s_waitcnt lgkmcnt(6)
  v_mfma_f32_16x16x32_bf16 v[36:39], v[32:35], v[84:87], v[36:39]
  s_waitcnt lgkmcnt(4)
  v_mfma_f32_16x16x32_bf16 v[40:43], v[32:35], v[88:91], v[40:43]
  s_waitcnt lgkmcnt(2)
  v_mfma_f32_16x16x32_bf16 v[44:47], v[32:35], v[92:95], v[44:47]
  s_waitcnt lgkmcnt(0)
  v_mfma_f32_16x16x32_bf16 v[48:51], v[32:35], v[96:99], v[48:51]
  s_add_u32 s31, s31, 1
  s_add_u32 s32, s32, 16384
  s_cmp_eq_u32 s32, 147456
  s_cselect_b32 s32, 0, s32
  v_mov_b32 v5, s31
  s_mov_b64 exec, 1
  ds_write_b32 v4, v5
  s_mov_b64 exec, -1
L_pv_done:
  s_add_u32 s37, s37, 1
  s_cmp_lt_u32 s37, s63
  s_cbranch_scc1 L_loop
  v_mov_b32 v5, 2048
  s_mov_b64 s[50:51], -1
L_gpoll_44:
  s_mov_b64 exec, s[50:51]
  s_cbranch_execz L_sk_46
  global_load_dwordx4 v[84:87], v5, s[24:25] sc1
L_sk_46:
  s_mov_b64 exec, -1
  s_sub_u32 s38, s38, 1
  s_cbranch_scc1 L_end
  s_waitcnt vmcnt(0)
  v_cmp_ne_u32 s[50:51], s41, v85
  v_cmp_ne_u32 vcc, s41, v87
  s_or_b64 s[50:51], s[50:51], vcc
  s_or_b64 vcc, s[50:51], s[50:51]
  s_cbranch_scc1 L_gpoll_44
  v_readfirstlane_b32 s60, v84
  v_readfirstlane_b32 s61, v86
  s_lshl_b32 s34, s26, 2
  s_and_b32 s35, s40, 1
  s_add_u32 s34, s34, s35
  s_lshl_b32 s34, s34, 14
  s_lshr_b32 s35, s40, 1
  s_lshl_b32 s35, s35, 13
  s_xor_b32 s35, s35, s60
  s_add_u32 s34, s34, s35
  s_lshl_b32 s35, s27, 8
  s_add_u32 s34, s34, s35
  s_add_u32 s34, s34, 1048576
  v_lshrrev_b32 v104, 1, v2
  v_lshlrev_b32 v104, 15, v104
  v_and_b32 v5, 1, v2
  v_lshl_or_b32 v104, v5, 12, v104
  v_lshl_or_b32 v104, v1, 4, v104
  v_add_u32 v104, s34, v104
  s_lshr_b32 s34, s2, 3
  s_lshl_b32 s34, s34, 1
  s_bfe_u32 s35, s2, 0x10001
  s_add_u32 s34, s34, s35
  s_lshl_b32 s34, s34, 14
  s_bfe_u32 s35, s2, 0x10002
  s_lshl_b32 s35, s35, 13
  s_xor_b32 s35, s35, s60
  s_add_u32 s34, s34, s35
  s_and_b32 s35, s2, 1
  s_lshl_b32 s35, s35, 12
  s_add_u32 s34, s34, s35
  s_add_u32 s34, s34, 1048576
  v_lshlrev_b32 v105, 4, v1
  v_lshl_or_b32 v105, v2, 10, v105
  v_add_u32 v105, s34, v105
  v_lshl_add_u32 v251, v0, 6, s34
  s_cmp_eq_u32 s40, 0
  s_cselect_b32 s62, 2147483647, 0
  s_cmp_ge_u32 s48, 64
  s_cbranch_scc1 L_nored
  s_sub_u32 s34, s40, 1
  s_cmp_ge_u32 s34, 2
  s_cbranch_scc1 L_nored
  s_lshl_b32 s34, s34, 14
  s_lshl_b32 s35, s48, 15
  s_add_u32 s34, s34, s35
  s_add_u32 s34, s34, s61
  s_add_u32 s34, s34, 2097152
  v_lshl_add_u32 v251, v0, 7, s34
  s_mov_b32 s62, 1
L_nored:
  s_lshl_b32 s34, s29, 2
  s_add_u32 s34, s34, s40
  s_lshl_b32 s34, s34, 18
  s_bfe_u32 s35, s2, 0x10006
  s_lshl_b32 s35, s35, 14
  s_add_u32 s34, s34, s35
  s_add_u32 s34, s34, s61
  s_and_b32 s35, s2, 63
  s_lshl_b32 s35, s35, 7
  s_add_u32 s34, s34, s35
  s_add_u32 s34, s34, 2097152
  v_lshrrev_b32 v5, 3, v0
  v_lshlrev_b32 v5, 15, v5
  v_and_b32 v6, 7, v0
  v_lshl_or_b32 v106, v6, 4, v5
  v_add_u32 v106, s34, v106
L_mini:
  s_cmp_eq_u32 s49, s31
  s_cbranch_scc1 L_fin
  s_cmp_gt_u32 s33, s31
  s_cbranch_scc1 L_have_47
L_poll_48:
  ds_read_b128 v[20:23], v3
  s_sub_u32 s38, s38, 1
  s_cbranch_scc1 L_end
  s_waitcnt lgkmcnt(0)
  v_readfirstlane_b32 s33, v20
  v_readfirstlane_b32 s49, v21
  v_readfirstlane_b32 s69, v22
  s_cmp_ge_u32 s49, s62
  s_cbranch_scc1 L_nw_49
  s_mov_b32 s62, 0
  global_load_dword v250, v251, s[24:25] sc1
L_nw_49:
  s_cmp_eq_u32 s49, s31
  s_cbranch_scc1 L_fin
  s_cmp_gt_u32 s33, s31
  s_cbranch_scc1 L_have_47
  s_branch L_poll_48
L_have_47:
  v_add_u32 v20, s32, v12
  v_add_u32 v21, s32, v13
  v_add_u32 v22, s32, v14
  v_add_u32 v23, s32, v15
  ds_read_b128 v[84:87], v20 offset:0
  ds_read_b128 v[88:91], v21 offset:0
  ds_read_b128 v[92:95], v22 offset:0
  ds_read_b128 v[96:99], v23 offset:0
  ds_read_b128 v[100:103], v20 offset:256
  s_waitcnt lgkmcnt(4)
  v_mfma_f32_16x16x32_bf16 v[24:27], v[84:87], v[52:55], 0
  ds_read_b128 v[84:87], v21 offset:256
  s_waitcnt lgkmcnt(4)
  v_mfma_f32_16x16x32_bf16 v[24:27], v[88:91], v[56:59], v[24:27]
  ds_read_b128 v[88:91], v22 offset:256
  s_waitcnt lgkmcnt(4)
  v_mfma_f32_16x16x32_bf16 v[24:27], v[92:95], v[60:63], v[24:27]
  ds_read_b128 v[92:95], v23 offset:256
  s_waitcnt lgkmcnt(4)
  v_mfma_f32_16x16x32_bf16 v[24:27], v[96:99], v[64:67], v[24:27]
  s_waitcnt lgkmcnt(3)
  v_mfma_f32_16x16x32_bf16 v[24:27], v[100:103], v[68:71], v[24:27]
  s_waitcnt lgkmcnt(2)
  v_mfma_f32_16x16x32_bf16 v[24:27], v[84:87], v[72:75], v[24:27]
  s_waitcnt lgkmcnt(1)
  v_mfma_f32_16x16x32_bf16 v[24:27], v[88:91], v[76:79], v[24:27]
  s_waitcnt lgkmcnt(0)
  v_mfma_f32_16x16x32_bf16 v[24:27], v[92:95], v[80:83], v[24:27]
  v_add_u32 v20, s32, v16
  v_add_u32 v21, s32, v17
  v_add_u32 v22, s32, v18
  v_add_u32 v23, s32, v19
  ds_read_b64_tr_b16 v[84:85], v20 offset:8192
  ds_read_b64_tr_b16 v[86:87], v21 offset:8192
  ds_read_b64_tr_b16 v[88:89], v22 offset:8192
  ds_read_b64_tr_b16 v[90:91], v23 offset:8192
  v_cvt_pk_bf16_f32 v32, v24, v25
  v_cvt_pk_bf16_f32 v33, v26, v27
  v_lshlrev_b32 v24, 16, v32
  v_and_b32 v25, 0xffff0000, v32
  v_lshlrev_b32 v26, 16, v33
  v_and_b32 v27, 0xffff0000, v33
  v_max3_f32 v11, v24, v25, v26
  v_max_f32 v11, v11, v27
  v_mov_b32 v5, v11
  s_nop 1
  v_permlane16_swap_b32 v11, v5
  v_max_f32 v11, v11, v5
  v_mov_b32 v5, v11
  s_nop 1
  v_permlane32_swap_b32 v11, v5
  v_max_f32 v11, v11, v5
  v_cmp_gt_f32 vcc, v11, v8
  s_cmp_lg_u64 vcc, 0
  s_cbranch_scc1 L_rescaleb
L_rescaledb:
  v_fma_f32 v24, v24, s46, -v9
  v_fma_f32 v25, v25, s46, -v9
  v_fma_f32 v26, v26, s46, -v9
  v_fma_f32 v27, v27, s46, -v9
  v_exp_f32 v24, v24
  v_exp_f32 v25, v25
  v_exp_f32 v26, v26
  v_exp_f32 v27, v27
  v_cvt_pk_bf16_f32 v32, v24, v25
  v_cvt_pk_bf16_f32 v33, v26, v27
  v_lshlrev_b32 v100, 16, v32
  v_and_b32 v101, 0xffff0000, v32
  v_pk_add_f32 v[100:101], v[24:25], v[100:101] neg_lo:[0,1] neg_hi:[0,1]
  v_cvt_pk_bf16_f32 v100, v100, v101
  v_cndmask_b32 v32, v32, v100, s[64:65]
  v_lshlrev_b32 v102, 16, v33
  v_and_b32 v103, 0xffff0000, v33
  v_pk_add_f32 v[102:103], v[26:27], v[102:103] neg_lo:[0,1] neg_hi:[0,1]
  v_cvt_pk_bf16_f32 v102, v102, v103
  v_cndmask_b32 v33, v33, v102, s[64:65]
  s_waitcnt lgkmcnt(0)
  s_nop 0
  v_mfma_f32_16x16x16_bf16 v[36:39], v[32:33], v[84:85], v[36:39]
  v_mfma_f32_16x16x16_bf16 v[40:43], v[32:33], v[86:87], v[40:43]
  v_mfma_f32_16x16x16_bf16 v[44:47], v[32:33], v[88:89], v[44:47]
  v_mfma_f32_16x16x16_bf16 v[48:51], v[32:33], v[90:91], v[48:51]
  v_add_f32 v5, v24, v25
  v_add_f32 v11, v26, v27
  v_add_f32 v10, v10, v5
  v_add_f32 v10, v10, v11
  s_add_u32 s31, s31, 1
  s_add_u32 s32, s32, 16384
  s_cmp_eq_u32 s32, 147456
  s_cselect_b32 s32, 0, s32
  s_cmp_eq_u32 s31, s49
  s_cbranch_scc1 L_fin
  v_mov_b32 v5, s31
  s_mov_b64 exec, 1
  ds_write_b32 v4, v5
  s_mov_b64 exec, -1
  s_branch L_mini
L_rescaleb:
  v_max_f32 v8, v8, v11
  v_mul_f32 v5, s46, v8
  v_sub_f32 v6, v9, v5
  v_mov_b32 v9, v5
  v_exp_f32 v6, v6
  s_nop 0
  v_mul_f32 v10, v10, v6
  v_mov_b32_dpp v5, v6 quad_perm:[0,0,2,2] row_mask:0xf bank_mask:0xf
  v_mov_b32_dpp v7, v6 quad_perm:[1,1,3,3] row_mask:0xf bank_mask:0xf
  v_mul_f32 v36, v36, v5
  v_mul_f32 v37, v37, v7
  v_mul_f32 v38, v38, v5
  v_mul_f32 v39, v39, v7
  v_mul_f32 v40, v40, v5
  v_mul_f32 v41, v41, v7
  v_mul_f32 v42, v42, v5
  v_mul_f32 v43, v43, v7
  v_mul_f32 v44, v44, v5
  v_mul_f32 v45, v45, v7
  v_mul_f32 v46, v46, v5
  v_mul_f32 v47, v47, v7
  v_mul_f32 v48, v48, v5
  v_mul_f32 v49, v49, v7
  v_mul_f32 v50, v50, v5
  v_mul_f32 v51, v51, v7
  s_branch L_rescaledb
L_pv_park:
  s_cmp_lg_u32 s37, 0
  s_cbranch_scc1 L_pk_50
  v_mfma_f32_16x16x32_bf16 v[36:39], v[32:35], v[136:139], v[36:39]
  v_mfma_f32_16x16x32_bf16 v[40:43], v[32:35], v[140:143], v[40:43]
  v_mfma_f32_16x16x32_bf16 v[44:47], v[32:35], v[144:147], v[44:47]
  v_mfma_f32_16x16x32_bf16 v[48:51], v[32:35], v[148:151], v[48:51]
  s_branch L_pv_done
L_pk_50:
  s_cmp_lg_u32 s37, 1
  s_cbranch_scc1 L_pk_51
  v_mfma_f32_16x16x32_bf16 v[36:39], v[32:35], v[152:155], v[36:39]
  v_mfma_f32_16x16x32_bf16 v[40:43], v[32:35], v[156:159], v[40:43]
  v_mfma_f32_16x16x32_bf16 v[44:47], v[32:35], v[160:163], v[44:47]
  v_mfma_f32_16x16x32_bf16 v[48:51], v[32:35], v[164:167], v[48:51]
  s_branch L_pv_done
L_pk_51:
  s_cmp_lg_u32 s37, 2
  s_cbranch_scc1 L_pk_52
  v_mfma_f32_16x16x32_bf16 v[36:39], v[32:35], v[168:171], v[36:39]
  v_mfma_f32_16x16x32_bf16 v[40:43], v[32:35], v[172:175], v[40:43]
  v_mfma_f32_16x16x32_bf16 v[44:47], v[32:35], v[176:179], v[44:47]
  v_mfma_f32_16x16x32_bf16 v[48:51], v[32:35], v[180:183], v[48:51]
  s_branch L_pv_done
L_pk_52:
  v_mfma_f32_16x16x32_bf16 v[36:39], v[32:35], v[184:187], v[36:39]
  v_mfma_f32_16x16x32_bf16 v[40:43], v[32:35], v[188:191], v[40:43]
  v_mfma_f32_16x16x32_bf16 v[44:47], v[32:35], v[192:195], v[44:47]
  v_mfma_f32_16x16x32_bf16 v[48:51], v[32:35], v[196:199], v[48:51]
  s_branch L_pv_done
L_ffn_addr:
  v_lshrrev_b32 v5, 3, v0
  v_and_b32 v6, 7, v0
  v_lshlrev_b32 v58, 9, v5
  v_lshl_or_b32 v58, v6, 4, v58
  s_add_u32 s34, s60, 16384
  v_add_u32 v58, s34, v58
  v_mul_u32_u24 v59, 224, v5
  v_lshl_add_u32 v59, v6, 2, v59
  v_add_u32 v59, 149504, v59
  v_and_b32 v60, 1, v0
  v_mul_u32_u24 v60, 896, v60
  v_lshl_add_u32 v60, v2, 4, v60
  v_add_u32 v60, 149504, v60
  s_lshl_b32 s34, s40, 5
  s_add_u32 s34, s34, 148224
  v_lshlrev_b32 v61, 7, v2
  v_lshl_add_u32 v61, v1, 1, v61
  v_add_u32 v61, s34, v61
  v_and_b32 v62, 1, v0
  v_lshlrev_b32 v62, 7, v62
  v_lshl_add_u32 v62, v2, 3, v62
  v_add_u32 v62, 148224, v62
  s_lshl_b32 s34, s40, 16
  s_lshl_b32 s35, s39, 7
  s_add_u32 s34, s34, s35
  s_add_u32 s34, s34, s60
  s_add_u32 s34, s34, 524288
  v_lshrrev_b32 v5, 3, v1
  v_lshlrev_b32 v5, 12, v5
  v_lshl_or_b32 v5, v2, 14, v5
  v_lshl_or_b32 v5, v6, 4, v5
  v_add_u32 v63, s34, v5
  s_branch L_addr_done
.p2align 12
L_fin:
  v_mov_b32 v5, v10
  s_nop 1
  v_permlane16_swap_b32 v10, v5
  v_add_f32 v10, v10, v5
  v_mov_b32 v5, v10
  s_nop 1
  v_permlane32_swap_b32 v10, v5
  v_add_f32 v10, v10, v5
  v_pk_add_f32 v[36:37], v[36:37], v[38:39]
  v_pk_add_f32 v[40:41], v[40:41], v[42:43]
  v_pk_add_f32 v[44:45], v[44:45], v[46:47]
  v_pk_add_f32 v[48:49], v[48:49], v[50:51]
  v_log_f32 v6, v10
  v_rcp_f32 v7, v10
  v_mov_b32 v87, s41
  v_add_f32 v6, v9, v6
  v_cndmask_b32 v84, v36, v44, s[42:43]
  v_cndmask_b32 v11, v37, v45, s[42:43]
  v_cndmask_b32 v84, v84, v11, s[44:45]
  v_mov_b32_dpp v5, v7 quad_perm:[0,0,2,2] row_mask:0x3 bank_mask:0xf
  v_mov_b32_dpp v86, v6 quad_perm:[0,0,2,2] row_mask:0x3 bank_mask:0xf
  v_cndmask_b32 v85, v40, v48, s[42:43]
  v_cndmask_b32 v11, v41, v49, s[42:43]
  v_cndmask_b32 v85, v85, v11, s[44:45]
  v_mov_b32_dpp v5, v7 quad_perm:[1,1,3,3] row_mask:0xc bank_mask:0xf
  v_mov_b32_dpp v86, v6 quad_perm:[1,1,3,3] row_mask:0xc bank_mask:0xf
  v_mul_f32 v84, v84, v5
  v_mul_f32 v85, v85, v5
  global_store_dwordx4 v104, v[84:87], s[24:25] sc1
  s_cmp_lg_u32 s62, 1
  s_cbranch_scc1 L_nobw
  global_load_dword v250, v251, s[24:25] sc1
L_nobw:
  v_lshlrev_b32 v56, 3, v2
  v_add_u32 v56, 147968, v56
  v_lshlrev_b32 v57, 1, v1
  v_add_u32 v57, 147968, v57
  v_mov_b32 v64, 0
  s_cmp_lt_u32 s39, 28
  s_cbranch_scc1 L_ffn_addr
  s_cmp_ge_u32 s48, 64
  s_cbranch_scc1 L_addr_done
  s_lshl_b32 s34, s48, 15
  s_lshr_b32 s35, s40, 1
  s_lshl_b32 s35, s35, 14
  s_add_u32 s34, s34, s35
  s_and_b32 s35, s40, 1
  s_lshl_b32 s35, s35, 12
  s_add_u32 s34, s34, s35
  s_add_u32 s34, s34, s61
  s_add_u32 s34, s34, 2097152
  v_lshl_add_u32 v58, v0, 4, s34
  s_lshl_b32 s34, s40, 6
  s_add_u32 s34, s34, 147712
  v_and_b32 v5, 7, v0
  v_lshl_add_u32 v59, v5, 2, s34
  v_and_b32 v5, 6, v0
  v_lshlrev_b32 v60, 2, v5
  v_add_u32 v60, 147712, v60
  s_lshl_b32 s34, s48, 6
  s_add_u32 s34, s34, s60
  s_add_u32 s34, s34, 16384
  v_lshl_add_u32 v61, v5, 3, s34
  s_lshr_b32 s34, s48, 1
  s_lshl_b32 s34, s34, 14
  s_and_b32 s35, s48, 1
  s_lshl_b32 s35, s35, 12
  s_add_u32 s34, s34, s35
  s_add_u32 s34, s34, s60
  s_add_u32 s34, s34, 524288
  v_lshl_add_u32 v62, v0, 4, s34
  v_lshl_add_u32 v63, v5, 1, s58
L_addr_done:
  s_cmp_lg_u32 s40, 0
  s_cbranch_scc1 L_a_nopoll
  global_load_dwordx4 v[88:91], v105, s[24:25] offset:0 sc1
  global_load_dwordx4 v[92:95], v105, s[24:25] offset:256 sc1
  global_load_dwordx4 v[96:99], v105, s[24:25] offset:512 sc1
  global_load_dwordx4 v[100:103], v105, s[24:25] offset:768 sc1
L_a_nopoll:
  v_lshrrev_b32 v5, 2, v1
  v_lshl_add_u32 v5, v2, 2, v5
  v_mul_u32_u24 v5, 896, v5
  v_and_b32 v6, 3, v1
  v_lshl_add_u32 v5, v6, 3, v5
  s_mul_i32 s34, s40, 224
  v_add_u32 v248, s34, v5
  s_cmp_gt_u32 s33, s31
  s_cbranch_scc1 L_have_53
L_poll_54:
  ds_read_b128 v[20:23], v3
  s_sub_u32 s38, s38, 1
  s_cbranch_scc1 L_end
  s_waitcnt lgkmcnt(0)
  v_readfirstlane_b32 s33, v20
  v_readfirstlane_b32 s49, v21
  v_readfirstlane_b32 s69, v22
  s_cmp_gt_u32 s33, s31
  s_cbranch_scc1 L_have_53
  s_sleep 1
  s_branch L_poll_54
L_have_53:
  v_add_u32 v20, s32, v248
  ds_read_b64_tr_b16 v[108:109], v20 offset:0
  ds_read_b64_tr_b16 v[112:113], v20 offset:32
  ds_read_b64_tr_b16 v[116:117], v20 offset:64
  ds_read_b64_tr_b16 v[120:121], v20 offset:96
  ds_read_b64_tr_b16 v[124:125], v20 offset:128
  ds_read_b64_tr_b16 v[128:129], v20 offset:160
  ds_read_b64_tr_b16 v[132:133], v20 offset:192
  s_waitcnt lgkmcnt(0)
  s_add_u32 s31, s31, 1
  s_add_u32 s32, s32, 16384
  s_cmp_eq_u32 s32, 147456
  s_cselect_b32 s32, 0, s32
  v_mov_b32 v5, s31
  s_mov_b64 exec, 1
  ds_write_b32 v4, v5
  s_mov_b64 exec, -1
  s_cmp_gt_u32 s33, s31
  s_cbranch_scc1 L_have_55
L_poll_56:
  ds_read_b128 v[20:23], v3
  s_sub_u32 s38, s38, 1
  s_cbranch_scc1 L_end
  s_waitcnt lgkmcnt(0)
  v_readfirstlane_b32 s33, v20
  v_readfirstlane_b32 s49, v21
  v_readfirstlane_b32 s69, v22
  s_cmp_gt_u32 s33, s31
  s_cbranch_scc1 L_have_55
  s_sleep 1
  s_branch L_poll_56
L_have_55:
  v_add_u32 v20, s32, v248
  ds_read_b64_tr_b16 v[110:111], v20 offset:0
  ds_read_b64_tr_b16 v[114:115], v20 offset:32
  ds_read_b64_tr_b16 v[118:119], v20 offset:64
  ds_read_b64_tr_b16 v[122:123], v20 offset:96
  ds_read_b64_tr_b16 v[126:127], v20 offset:128
  ds_read_b64_tr_b16 v[130:131], v20 offset:160
  ds_read_b64_tr_b16 v[134:135], v20 offset:192
  s_waitcnt lgkmcnt(0)
  s_add_u32 s31, s31, 1
  s_add_u32 s32, s32, 16384
  s_cmp_eq_u32 s32, 147456
  s_cselect_b32 s32, 0, s32
  v_mov_b32 v5, s31
  s_mov_b64 exec, 1
  ds_write_b32 v4, v5
  s_mov_b64 exec, -1
  s_cmp_lg_u32 s40, 0
  s_cbranch_scc1 L_a_join
  s_branch L_gchk_58
L_gpoll_57:
  s_mov_b64 exec, s[50:51]
  s_cbranch_execz L_sk_59
  global_load_dwordx4 v[88:91], v105, s[24:25] offset:0 sc1
L_sk_59:
  s_mov_b64 exec, s[52:53]
  s_cbranch_execz L_sk_60
  global_load_dwordx4 v[92:95], v105, s[24:25] offset:256 sc1
L_sk_60:
  s_mov_b64 exec, s[54:55]
  s_cbranch_execz L_sk_61
  global_load_dwordx4 v[96:99], v105, s[24:25] offset:512 sc1
L_sk_61:
  s_mov_b64 exec, s[56:57]
  s_cbranch_execz L_sk_62
  global_load_dwordx4 v[100:103], v105, s[24:25] offset:768 sc1
L_sk_62:
  s_mov_b64 exec, -1
  s_sub_u32 s38, s38, 1
  s_cbranch_scc1 L_end
L_gchk_58:
  s_waitcnt vmcnt(0)
  v_cmp_ne_u32 s[50:51], s41, v91
  v_cmp_ne_u32 s[52:53], s41, v95
  v_cmp_ne_u32 s[54:55], s41, v99
  v_cmp_ne_u32 s[56:57], s41, v103
  s_or_b64 vcc, s[50:51], s[52:53]
  s_or_b64 vcc, vcc, s[54:55]
  s_or_b64 vcc, vcc, s[56:57]
  s_cbranch_scc1 L_gpoll_57
  v_max3_f32 v11, v90, v94, v98
  v_max_f32 v11, v11, v102
  v_mov_b32 v5, v11
  s_nop 1
  v_permlane16_swap_b32 v11, v5
  v_max_f32 v11, v11, v5
  v_mov_b32 v5, v11
  s_nop 1
  v_permlane32_swap_b32 v11, v5
  v_max_f32 v11, v11, v5
  v_sub_f32 v90, v90, v11
  v_sub_f32 v94, v94, v11
  v_sub_f32 v98, v98, v11
  v_sub_f32 v102, v102, v11
  v_exp_f32 v90, v90
  v_exp_f32 v94, v94
  v_exp_f32 v98, v98
  v_exp_f32 v102, v102
  v_mul_f32 v24, v88, v90
  v_mul_f32 v25, v89, v90
  v_add_f32 v26, v90, v94
  v_fmac_f32 v24, v92, v94
  v_fmac_f32 v25, v93, v94
  v_fmac_f32 v24, v96, v98
  v_fmac_f32 v25, v97, v98
  v_add_f32 v26, v26, v98
  v_fmac_f32 v24, v100, v102
  v_fmac_f32 v25, v101, v102
  v_add_f32 v26, v26, v102
  v_mov_b32 v27, v26
  v_mov_b32 v28, v24
  v_mov_b32 v29, v25
  v_permlane16_swap_b32 v26, v27
  v_permlane16_swap_b32 v24, v28
  v_permlane16_swap_b32 v25, v29
  v_add_f32 v26, v26, v27
  v_add_f32 v24, v24, v28
  v_add_f32 v25, v25, v29
  v_mov_b32 v27, v26
  v_mov_b32 v28, v24
  v_mov_b32 v29, v25
  v_permlane32_swap_b32 v26, v27
  v_permlane32_swap_b32 v24, v28
  v_permlane32_swap_b32 v25, v29
  v_add_f32 v26, v26, v27
  v_add_f32 v24, v24, v28
  v_add_f32 v25, v25, v29
  v_rcp_f32 v26, v26
  s_nop 0
  v_mul_f32 v24, v24, v26
  v_mul_f32 v25, v25, v26
  s_nop 0
  v_mov_b32_dpp v27, v24 quad_perm:[1,0,3,2] row_mask:0xf bank_mask:0xf
  v_mov_b32_dpp v28, v25 quad_perm:[1,0,3,2] row_mask:0xf bank_mask:0xf
  v_cvt_pk_bf16_f32 v24, v24, v27
  v_cvt_pk_bf16_f32 v25, v25, v28
  s_mov_b64 exec, 0x5555
  ds_write2_b32 v57, v24, v25 offset0:0 offset1:8
  s_mov_b64 exec, -1
  s_waitcnt lgkmcnt(0)
L_a_join:
  s_barrier
  ds_read2_b64 v[52:55], v56 offset0:0 offset1:4
  v_mov_b32 v85, s41
  s_waitcnt lgkmcnt(0)
  v_mfma_f32_16x16x32_bf16 v[36:39], v[52:55], v[108:111], 0
  v_mfma_f32_16x16x32_bf16 v[44:47], v[52:55], v[116:119], 0
  v_mfma_f32_16x16x32_bf16 v[68:71], v[52:55], v[124:127], 0
  v_mfma_f32_16x16x32_bf16 v[76:79], v[52:55], v[132:135], 0
  v_mfma_f32_16x16x32_bf16 v[40:43], v[52:55], v[112:115], 0
  v_mfma_f32_16x16x32_bf16 v[48:51], v[52:55], v[120:123], 0
  v_mfma_f32_16x16x32_bf16 v[72:75], v[52:55], v[128:131], 0
  s_nop 2
  v_cndmask_b32 v84, v36, v44, s[42:43]
  s_nop 0
  v_cndmask_b32 v11, v68, v76, s[42:43]
  v_cndmask_b32 v84, v84, v11, s[44:45]
  v_cndmask_b32 v86, v40, v48, s[42:43]
  v_cndmask_b32 v5, v72, v64, s[42:43]
  v_cndmask_b32 v86, v86, v5, s[44:45]
  global_store_dwordx4 v106, v[84:87], s[24:25] sc1
  s_cmp_lt_u32 s39, 28
  s_cbranch_scc1 L_ffn
  s_cmp_ge_u32 s48, 64
  s_cbranch_scc1 L_done
  v_lshlrev_b32 v36, 16, v254
  v_and_b32 v37, 0xffff0000, v254
  v_lshlrev_b32 v38, 16, v255
  v_and_b32 v39, 0xffff0000, v255
  s_mov_b64 s[50:51], -1
  s_mov_b64 s[52:53], -1
  s_mov_b64 s[54:55], -1
  s_mov_b64 s[56:57], -1
L_gpoll_63:
  s_mov_b64 exec, s[50:51]
  s_cbranch_execz L_sk_65
  global_load_dwordx4 v[88:91], v58, s[24:25] offset:0 sc1
L_sk_65:
  s_mov_b64 exec, s[52:53]
  s_cbranch_execz L_sk_66
  global_load_dwordx4 v[92:95], v58, s[24:25] offset:1024 sc1
L_sk_66:
  s_mov_b64 exec, s[54:55]
  s_cbranch_execz L_sk_67
  global_load_dwordx4 v[96:99], v58, s[24:25] offset:2048 sc1
L_sk_67:
  s_mov_b64 exec, s[56:57]
  s_cbranch_execz L_sk_68
  global_load_dwordx4 v[100:103], v58, s[24:25] offset:3072 sc1
L_sk_68:
  s_mov_b64 exec, -1
  s_sub_u32 s38, s38, 1
  s_cbranch_scc1 L_end
  s_waitcnt vmcnt(0)
  v_cmp_ne_u32 s[50:51], s41, v91
  v_cmp_ne_u32 s[52:53], s41, v95
  v_cmp_ne_u32 s[54:55], s41, v99
  v_cmp_ne_u32 s[56:57], s41, v103
  s_or_b64 vcc, s[50:51], s[52:53]
  s_or_b64 vcc, vcc, s[54:55]
  s_or_b64 vcc, vcc, s[56:57]
  s_cbranch_scc1 L_gpoll_63
  v_add_f32 v24, v88, v92
  v_add_f32 v25, v90, v94
  v_add_f32 v26, v96, v100
  v_add_f32 v27, v98, v102
  v_add_f32 v24, v24, v26
  v_add_f32 v25, v25, v27
  s_nop 0
  v_add_f32_dpp v24, v24, v24 row_ror:8 row_mask:0xf bank_mask:0xf
  v_add_f32_dpp v25, v25, v25 row_ror:8 row_mask:0xf bank_mask:0xf
  v_mov_b32 v26, v24
  v_mov_b32 v27, v25
  s_nop 0
  v_permlane16_swap_b32 v24, v26
  v_permlane16_swap_b32 v25, v27
  v_add_f32 v24, v24, v26
  v_add_f32 v25, v25, v27
  v_mov_b32 v26, v24
  v_mov_b32 v27, v25
  s_nop 0
  v_permlane32_swap_b32 v24, v26
  v_permlane32_swap_b32 v25, v27
  v_add_f32 v24, v24, v26
  v_add_f32 v25, v25, v27
  s_mov_b64 exec, 0xff
  ds_write2_b32 v59, v24, v25 offset0:0 offset1:8
  s_mov_b64 exec, -1
  s_waitcnt lgkmcnt(0)
  s_barrier
  s_cmp_lg_u32 s40, 0
  s_cbranch_scc1 L_done
  ds_read2_b64 v[88:91], v60 offset0:0 offset1:4
  ds_read2_b64 v[92:95], v60 offset0:8 offset1:12
  ds_read2_b64 v[96:99], v60 offset0:16 offset1:20
  ds_read2_b64 v[100:103], v60 offset0:24 offset1:28
  s_waitcnt lgkmcnt(2)
  v_pk_add_f32 v[88:89], v[88:89], v[92:93]
  v_pk_add_f32 v[90:91], v[90:91], v[94:95]
  s_waitcnt lgkmcnt(0)
  v_pk_add_f32 v[96:97], v[96:97], v[100:101]
  v_pk_add_f32 v[98:99], v[98:99], v[102:103]
  v_pk_add_f32 v[88:89], v[88:89], v[96:97]
  v_pk_add_f32 v[90:91], v[90:91], v[98:99]
  v_cvt_pk_bf16_f32 v84, v88, v89
  v_cvt_pk_bf16_f32 v86, v90, v91
  v_lshlrev_b32 v88, 16, v84
  v_and_b32 v89, 0xffff0000, v84
  v_lshlrev_b32 v90, 16, v86
  v_and_b32 v91, 0xffff0000, v86
  v_pk_add_f32 v[88:89], v[88:89], v[36:37]
  v_pk_add_f32 v[90:91], v[90:91], v[38:39]
  v_cvt_pk_bf16_f32 v84, v88, v89
  v_cvt_pk_bf16_f32 v86, v90, v91
  s_mov_b64 exec, 0x55
  global_store_dwordx4 v61, v[84:87], s[24:25] sc1
  s_mov_b64 exec, -1
  v_lshlrev_b32 v36, 16, v84
  v_and_b32 v37, 0xffff0000, v84
  v_lshlrev_b32 v38, 16, v86
  v_and_b32 v39, 0xffff0000, v86
  v_mov_b32 v100, 0
  v_mov_b32 v101, s41
  v_mov_b32 v102, 0
  v_mov_b32 v103, s41
  s_mov_b64 s[50:51], -1
  s_mov_b64 s[52:53], -1
  s_mov_b64 s[54:55], -1
  s_mov_b64 s[56:57], s[66:67]
L_gpoll_69:
  s_mov_b64 exec, s[50:51]
  s_cbranch_execz L_sk_71
  global_load_dwordx4 v[88:91], v62, s[24:25] offset:0 sc1
L_sk_71:
  s_mov_b64 exec, s[52:53]
  s_cbranch_execz L_sk_72
  global_load_dwordx4 v[92:95], v62, s[24:25] offset:1024 sc1
L_sk_72:
  s_mov_b64 exec, s[54:55]
  s_cbranch_execz L_sk_73
  global_load_dwordx4 v[96:99], v62, s[24:25] offset:2048 sc1
L_sk_73:
  s_mov_b64 exec, s[56:57]
  s_cbranch_execz L_sk_74
  global_load_dwordx4 v[100:103], v62, s[24:25] offset:3072 sc1
L_sk_74:
  s_mov_b64 exec, -1
  s_sub_u32 s38, s38, 1
  s_cbranch_scc1 L_end
  s_waitcnt vmcnt(0)
  v_cmp_ne_u32 s[50:51], s41, v91
  v_cmp_ne_u32 s[52:53], s41, v95
  v_cmp_ne_u32 s[54:55], s41, v99
  v_cmp_ne_u32 s[56:57], s41, v103
  s_or_b64 vcc, s[50:51], s[52:53]
  s_or_b64 vcc, vcc, s[54:55]
  s_or_b64 vcc, vcc, s[56:57]
  s_cbranch_scc1 L_gpoll_69
  v_add_f32 v24, v88, v92
  v_add_f32 v25, v90, v94
  v_add_f32 v26, v96, v100
  v_add_f32 v27, v98, v102
  v_add_f32 v24, v24, v26
  v_add_f32 v25, v25, v27
  s_nop 0
  v_add_f32_dpp v24, v24, v24 row_ror:8 row_mask:0xf bank_mask:0xf
  v_add_f32_dpp v25, v25, v25 row_ror:8 row_mask:0xf bank_mask:0xf
  v_mov_b32 v26, v24
  v_mov_b32 v27, v25
  s_nop 0
  v_permlane16_swap_b32 v24, v26
  v_permlane16_swap_b32 v25, v27
  v_add_f32 v24, v24, v26
  v_add_f32 v25, v25, v27
  v_mov_b32 v26, v24
  v_mov_b32 v27, v25
  s_nop 0
  v_permlane32_swap_b32 v24, v26
  v_permlane32_swap_b32 v25, v27
  v_add_f32 v24, v24, v26
  v_add_f32 v25, v25, v27
  s_nop 0
  v_mov_b32_dpp v88, v24 quad_perm:[0,0,2,2] row_mask:0xf bank_mask:0xf
  v_mov_b32_dpp v89, v24 quad_perm:[1,1,3,3] row_mask:0xf bank_mask:0xf
  v_mov_b32_dpp v90, v25 quad_perm:[0,0,2,2] row_mask:0xf bank_mask:0xf
  v_mov_b32_dpp v91, v25 quad_perm:[1,1,3,3] row_mask:0xf bank_mask:0xf
  v_cvt_pk_bf16_f32 v92, v88, v89
  v_cvt_pk_bf16_f32 v94, v90, v91
  v_lshlrev_b32 v88, 16, v92
  v_and_b32 v89, 0xffff0000, v92
  v_lshlrev_b32 v90, 16, v94
  v_and_b32 v91, 0xffff0000, v94
  v_pk_add_f32 v[88:89], v[88:89], v[36:37]
  v_pk_add_f32 v[90:91], v[90:91], v[38:39]
  v_cvt_pk_bf16_f32 v92, v88, v89
  v_cvt_pk_bf16_f32 v94, v90, v91
  s_mov_b64 exec, 0x55
  global_store_dword v63, v92, s[20:21] sc1
  s_cmp_eq_u32 s59, 3
  s_cbranch_scc1 L_done
  global_store_dword v63, v94, s[20:21] offset:32 sc1
  s_cmp_lg_u32 s48, 0
  s_cbranch_scc1 L_done
  s_add_u32 s34, s47, 1
  v_mov_b32 v6, s34
  v_mov_b32 v7, 0
  s_mov_b64 exec, 1
  global_store_dword v7, v6, s[24:25] sc1
  s_branch L_done
L_ffn:
  s_cmp_lg_u32 s40, 0
  s_cbranch_scc1 L_c_join
  s_mov_b64 s[50:51], -1
  s_mov_b64 s[52:53], -1
  s_mov_b64 s[54:55], -1
  s_mov_b64 s[56:57], -1
L_gpoll_75:
  s_mov_b64 exec, s[50:51]
  s_cbranch_execz L_sk_77
  global_load_dwordx4 v[88:91], v58, s[24:25] offset:0 sc1
L_sk_77:
  s_mov_b64 exec, s[52:53]
  s_cbranch_execz L_sk_78
  global_load_dwordx4 v[92:95], v58, s[24:25] offset:128 sc1
L_sk_78:
  s_mov_b64 exec, s[54:55]
  s_cbranch_execz L_sk_79
  global_load_dwordx4 v[96:99], v58, s[24:25] offset:256 sc1
L_sk_79:
  s_mov_b64 exec, s[56:57]
  s_cbranch_execz L_sk_80
  global_load_dwordx4 v[100:103], v58, s[24:25] offset:384 sc1
L_sk_80:
  s_mov_b64 exec, -1
  s_sub_u32 s38, s38, 1
  s_cbranch_scc1 L_end
  s_waitcnt vmcnt(0)
  v_cmp_ne_u32 s[50:51], s41, v91
  v_cmp_ne_u32 s[52:53], s41, v95
  v_cmp_ne_u32 s[54:55], s41, v99
  v_cmp_ne_u32 s[56:57], s41, v103
  s_or_b64 vcc, s[50:51], s[52:53]
  s_or_b64 vcc, vcc, s[54:55]
  s_or_b64 vcc, vcc, s[56:57]
  s_cbranch_scc1 L_gpoll_75
  v_lshlrev_b32 v36, 16, v88
  v_and_b32 v37, 0xffff0000, v88
  v_lshlrev_b32 v38, 16, v90
  v_and_b32 v39, 0xffff0000, v90
  v_lshlrev_b32 v40, 16, v92
  v_and_b32 v41, 0xffff0000, v92
  v_lshlrev_b32 v42, 16, v94
  v_and_b32 v43, 0xffff0000, v94
  v_lshlrev_b32 v44, 16, v96
  v_and_b32 v45, 0xffff0000, v96
  v_lshlrev_b32 v46, 16, v98
  v_and_b32 v47, 0xffff0000, v98
  v_lshlrev_b32 v48, 16, v100
  v_and_b32 v49, 0xffff0000, v100
  v_pk_add_f32 v[250:251], v[36:37], v[38:39]
  v_pk_add_f32 v[252:253], v[40:41], v[42:43]
  v_pk_add_f32 v[250:251], v[250:251], v[44:45]
  v_pk_add_f32 v[252:253], v[252:253], v[46:47]
  v_pk_add_f32 v[250:251], v[250:251], v[48:49]
  v_pk_add_f32 v[250:251], v[250:251], v[252:253]
  v_add_f32 v5, v250, v251
  s_nop 1
  v_add_f32_dpp v5, v5, v5 row_ror:8 row_mask:0xf bank_mask:0xf
  s_nop 1
  v_add_f32_dpp v5, v5, v5 row_ror:4 row_mask:0xf bank_mask:0xf
  s_nop 1
  v_add_f32_dpp v5, v5, v5 row_ror:2 row_mask:0xf bank_mask:0xf
  s_nop 1
  v_add_f32_dpp v5, v5, v5 row_ror:1 row_mask:0xf bank_mask:0xf
  v_mov_b32 v6, v5
  s_nop 1
  v_permlane16_swap_b32 v5, v6
  v_add_f32 v5, v5, v6
  v_mul_f32 v248, 0x3b124925, v5
  v_pk_add_f32 v[252:253], v[36:37], v[248:249] op_sel_hi:[1,0] neg_lo:[0,1] neg_hi:[0,1]
  v_pk_mul_f32 v[250:251], v[252:253], v[252:253]
  v_pk_add_f32 v[252:253], v[38:39], v[248:249] op_sel_hi:[1,0] neg_lo:[0,1] neg_hi:[0,1]
  v_pk_fma_f32 v[250:251], v[252:253], v[252:253], v[250:251]
  v_pk_add_f32 v[252:253], v[40:41], v[248:249] op_sel_hi:[1,0] neg_lo:[0,1] neg_hi:[0,1]
  v_pk_fma_f32 v[250:251], v[252:253], v[252:253], v[250:251]
  v_pk_add_f32 v[252:253], v[42:43], v[248:249] op_sel_hi:[1,0] neg_lo:[0,1] neg_hi:[0,1]
  v_pk_fma_f32 v[250:251], v[252:253], v[252:253], v[250:251]
  v_pk_add_f32 v[252:253], v[44:45], v[248:249] op_sel_hi:[1,0] neg_lo:[0,1] neg_hi:[0,1]
  v_pk_fma_f32 v[250:251], v[252:253], v[252:253], v[250:251]
  v_pk_add_f32 v[252:253], v[46:47], v[248:249] op_sel_hi:[1,0] neg_lo:[0,1] neg_hi:[0,1]
  v_pk_fma_f32 v[250:251], v[252:253], v[252:253], v[250:251]
  v_pk_add_f32 v[252:253], v[48:49], v[248:249] op_sel_hi:[1,0] neg_lo:[0,1] neg_hi:[0,1]
  v_pk_fma_f32 v[250:251], v[252:253], v[252:253], v[250:251]
  v_add_f32 v5, v250, v251
  v_cvt_pk_bf16_f32 v248, v248, v248
  v_and_b32 v248, 0xffff0000, v248
  v_pk_add_f32 v[36:37], v[36:37], v[248:249] op_sel_hi:[1,0] neg_lo:[0,1] neg_hi:[0,1]
  v_pk_add_f32 v[38:39], v[38:39], v[248:249] op_sel_hi:[1,0] neg_lo:[0,1] neg_hi:[0,1]
  v_add_f32_dpp v5, v5, v5 row_ror:8 row_mask:0xf bank_mask:0xf
  v_pk_add_f32 v[40:41], v[40:41], v[248:249] op_sel_hi:[1,0] neg_lo:[0,1] neg_hi:[0,1]
  v_pk_add_f32 v[42:43], v[42:43], v[248:249] op_sel_hi:[1,0] neg_lo:[0,1] neg_hi:[0,1]
  v_add_f32_dpp v5, v5, v5 row_ror:4 row_mask:0xf bank_mask:0xf
  v_pk_add_f32 v[44:45], v[44:45], v[248:249] op_sel_hi:[1,0] neg_lo:[0,1] neg_hi:[0,1]
  v_pk_add_f32 v[46:47], v[46:47], v[248:249] op_sel_hi:[1,0] neg_lo:[0,1] neg_hi:[0,1]
  v_add_f32_dpp v5, v5, v5 row_ror:2 row_mask:0xf bank_mask:0xf
  v_pk_add_f32 v[48:49], v[48:49], v[248:249] op_sel_hi:[1,0] neg_lo:[0,1] neg_hi:[0,1]
  v_cvt_pk_bf16_f32 v88, v36, v37
  v_add_f32_dpp v5, v5, v5 row_ror:1 row_mask:0xf bank_mask:0xf
  v_cvt_pk_bf16_f32 v90, v38, v39
  v_cvt_pk_bf16_f32 v92, v40, v41
  v_mov_b32 v6, v5
  v_cvt_pk_bf16_f32 v94, v42, v43
  v_cvt_pk_bf16_f32 v96, v44, v45
  v_permlane16_swap_b32 v5, v6
  v_cvt_pk_bf16_f32 v98, v46, v47
  v_cvt_pk_bf16_f32 v100, v48, v49
  v_add_f32 v5, v5, v6
  v_lshlrev_b32 v36, 16, v88
  v_and_b32 v37, 0xffff0000, v88
  v_mul_f32 v5, 0x3b124925, v5
  v_lshlrev_b32 v38, 16, v90
  v_and_b32 v39, 0xffff0000, v90
  v_cvt_pk_bf16_f32 v5, v5, v5
  v_lshlrev_b32 v40, 16, v92
  v_and_b32 v41, 0xffff0000, v92
  v_and_b32 v5, 0xffff0000, v5
  v_lshlrev_b32 v42, 16, v94
  v_and_b32 v43, 0xffff0000, v94
  v_add_f32 v5, 0x3727c5ac, v5
  v_lshlrev_b32 v44, 16, v96
  v_and_b32 v45, 0xffff0000, v96
  v_cvt_pk_bf16_f32 v5, v5, v5
  v_lshlrev_b32 v46, 16, v98
  v_and_b32 v47, 0xffff0000, v98
  v_and_b32 v5, 0xffff0000, v5
  v_lshlrev_b32 v48, 16, v100
  v_and_b32 v49, 0xffff0000, v100
  v_sqrt_f32 v5, v5
  s_nop 0
  v_cvt_pk_bf16_f32 v5, v5, v5
  v_and_b32 v5, 0xffff0000, v5
  v_rcp_f32 v250, v5
  s_nop 0
  v_pk_mul_f32 v[36:37], v[36:37], v[250:251] op_sel_hi:[1,0]
  v_pk_mul_f32 v[38:39], v[38:39], v[250:251] op_sel_hi:[1,0]
  v_pk_mul_f32 v[40:41], v[40:41], v[250:251] op_sel_hi:[1,0]
  v_pk_mul_f32 v[42:43], v[42:43], v[250:251] op_sel_hi:[1,0]
  v_pk_mul_f32 v[44:45], v[44:45], v[250:251] op_sel_hi:[1,0]
  v_pk_mul_f32 v[46:47], v[46:47], v[250:251] op_sel_hi:[1,0]
  v_pk_mul_f32 v[48:49], v[48:49], v[250:251] op_sel_hi:[1,0]
  v_cvt_pk_bf16_f32 v88, v36, v37
  ds_write_b32 v59, v88 offset:0
  v_cvt_pk_bf16_f32 v90, v38, v39
  ds_write_b32 v59, v90 offset:32
  v_cvt_pk_bf16_f32 v92, v40, v41
  ds_write_b32 v59, v92 offset:64
  v_cvt_pk_bf16_f32 v94, v42, v43
  ds_write_b32 v59, v94 offset:96
  v_cvt_pk_bf16_f32 v96, v44, v45
  ds_write_b32 v59, v96 offset:128
  v_cvt_pk_bf16_f32 v98, v46, v47
  ds_write_b32 v59, v98 offset:160
  v_cvt_pk_bf16_f32 v100, v48, v49
  ds_write_b32 v59, v100 offset:192
  s_waitcnt lgkmcnt(0)
L_c_join:
  s_barrier
  ds_read_b128 v[84:87], v60 offset:0
  ds_read_b128 v[88:91], v60 offset:64
  ds_read_b128 v[92:95], v60 offset:128
  ds_read_b128 v[96:99], v60 offset:192
  ds_read_b128 v[100:103], v60 offset:256
  s_waitcnt lgkmcnt(4)
  v_mfma_f32_16x16x32_bf16 v[24:27], v[84:87], v[136:139], 0
  ds_read_b128 v[84:87], v60 offset:320
  s_waitcnt lgkmcnt(4)
  v_mfma_f32_16x16x32_bf16 v[24:27], v[88:91], v[140:143], v[24:27]
  ds_read_b128 v[88:91], v60 offset:384
  s_waitcnt lgkmcnt(4)
  v_mfma_f32_16x16x32_bf16 v[24:27], v[92:95], v[144:147], v[24:27]
  ds_read_b128 v[92:95], v60 offset:448
  s_waitcnt lgkmcnt(4)
  v_mfma_f32_16x16x32_bf16 v[24:27], v[96:99], v[148:151], v[24:27]
  ds_read_b128 v[96:99], v60 offset:512
  s_waitcnt lgkmcnt(4)
  v_mfma_f32_16x16x32_bf16 v[24:27], v[100:103], v[152:155], v[24:27]
  ds_read_b128 v[100:103], v60 offset:576
  s_waitcnt lgkmcnt(4)
  v_mfma_f32_16x16x32_bf16 v[24:27], v[84:87], v[156:159], v[24:27]
  ds_read_b128 v[84:87], v60 offset:640
  s_waitcnt lgkmcnt(4)
  v_mfma_f32_16x16x32_bf16 v[24:27], v[88:91], v[160:163], v[24:27]
  ds_read_b128 v[88:91], v60 offset:704
  s_waitcnt lgkmcnt(4)
  v_mfma_f32_16x16x32_bf16 v[24:27], v[92:95], v[164:167], v[24:27]
  ds_read_b128 v[92:95], v60 offset:768
  s_waitcnt lgkmcnt(4)
  v_mfma_f32_16x16x32_bf16 v[24:27], v[96:99], v[168:171], v[24:27]
  ds_read_b128 v[96:99], v60 offset:832
  s_waitcnt lgkmcnt(4)
  v_mfma_f32_16x16x32_bf16 v[24:27], v[100:103], v[172:175], v[24:27]
  s_waitcnt lgkmcnt(3)
  v_mfma_f32_16x16x32_bf16 v[24:27], v[84:87], v[176:179], v[24:27]
  s_waitcnt lgkmcnt(2)
  v_mfma_f32_16x16x32_bf16 v[24:27], v[88:91], v[180:183], v[24:27]
  s_waitcnt lgkmcnt(1)
  v_mfma_f32_16x16x32_bf16 v[24:27], v[92:95], v[184:187], v[24:27]
  s_waitcnt lgkmcnt(0)
  v_mfma_f32_16x16x32_bf16 v[24:27], v[96:99], v[188:191], v[24:27]
  v_mov_b32 v37, s41
  v_mov_b32 v39, s41
  v_mov_b32 v41, s41
  v_mov_b32 v43, s41
  v_add_u32 v58, 262144, v63
  s_nop 2
  v_cndmask_b32 v5, v24, v25, s[42:43]
  v_cvt_pk_bf16_f32 v5, v5, v5
  v_and_b32 v5, 0xffff0000, v5
  v_mul_f32 v6, 0xbfb8aa3b, v5
  v_exp_f32 v6, v6
  s_nop 0
  v_add_f32 v6, 1.0, v6
  v_rcp_f32 v6, v6
  s_nop 0
  v_mul_f32 v5, v5, v6
  v_cvt_pk_bf16_f32 v5, v5, v5
  s_mov_b32 exec_hi, 0
  ds_write_b16 v61, v5
  s_mov_b32 exec_hi, -1
  s_waitcnt lgkmcnt(0)
  s_barrier
  ds_read2_b64 v[84:87], v62 offset0:0 offset1:4
  ds_read2_b64 v[88:91], v62 offset0:8 offset1:12
  s_waitcnt lgkmcnt(1)
  v_mfma_f32_16x16x32_bf16 v[136:139], v[84:87], v[192:195], 0
  v_mfma_f32_16x16x32_bf16 v[144:147], v[84:87], v[200:203], 0
  v_mfma_f32_16x16x32_bf16 v[152:155], v[84:87], v[208:211], 0
  v_mfma_f32_16x16x32_bf16 v[160:163], v[84:87], v[216:219], 0
  v_mfma_f32_16x16x32_bf16 v[140:143], v[84:87], v[196:199], 0
  v_mfma_f32_16x16x32_bf16 v[148:151], v[84:87], v[204:207], 0
  v_mfma_f32_16x16x32_bf16 v[156:159], v[84:87], v[212:215], 0
  s_waitcnt lgkmcnt(0)
  v_mfma_f32_16x16x32_bf16 v[136:139], v[88:91], v[220:223], v[136:139]
  v_mfma_f32_16x16x32_bf16 v[144:147], v[88:91], v[228:231], v[144:147]
  v_mfma_f32_16x16x32_bf16 v[152:155], v[88:91], v[236:239], v[152:155]
  v_mfma_f32_16x16x32_bf16 v[160:163], v[88:91], v[244:247], v[160:163]
  v_mfma_f32_16x16x32_bf16 v[140:143], v[88:91], v[224:227], v[140:143]
  v_mfma_f32_16x16x32_bf16 v[148:151], v[88:91], v[232:235], v[148:151]
  v_mfma_f32_16x16x32_bf16 v[156:159], v[88:91], v[240:243], v[156:159]
  s_nop 2
  v_cndmask_b32 v36, v136, v144, s[42:43]
  s_nop 0
  v_cndmask_b32 v11, v152, v160, s[42:43]
  v_cndmask_b32 v36, v36, v11, s[44:45]
  v_cndmask_b32 v40, v137, v145, s[42:43]
  v_cndmask_b32 v11, v153, v161, s[42:43]
  v_cndmask_b32 v40, v40, v11, s[44:45]
  v_cndmask_b32 v38, v140, v148, s[42:43]
  v_cndmask_b32 v11, v156, v64, s[42:43]
  v_cndmask_b32 v38, v38, v11, s[44:45]
  global_store_dwordx4 v63, v[36:39], s[24:25] sc1
  v_cndmask_b32 v42, v141, v149, s[42:43]
  v_cndmask_b32 v11, v157, v64, s[42:43]
  v_cndmask_b32 v42, v42, v11, s[44:45]
  global_store_dwordx4 v58, v[40:43], s[24:25] sc1
L_done:
L_end:
  s_endpgm
L_ffn_w:
  v_lshrrev_b32 v5, 2, v1
  v_lshl_add_u32 v5, v2, 2, v5
  v_mul_u32_u24 v5, 896, v5
  v_and_b32 v6, 3, v1
  v_lshl_add_u32 v5, v6, 3, v5
  s_mul_i32 s34, s40, 224
  v_add_u32 v248, s34, v5
  v_lshrrev_b32 v5, 3, v1
  v_and_b32 v6, 1, v2
  v_lshl_or_b32 v5, v6, 1, v5
  v_xor_b32 v5, s40, v5
  v_lshlrev_b32 v5, 5, v5
  v_and_b32 v6, 3, v1
  v_lshl_or_b32 v5, v6, 3, v5
  v_lshrrev_b32 v6, 2, v1
  v_lshl_or_b32 v5, v6, 7, v5
  v_lshl_or_b32 v249, v2, 10, v5
  s_cmp_gt_u32 s33, s31
  s_cbranch_scc1 L_have_81
L_poll_82:
  ds_read_b128 v[20:23], v3
  s_sub_u32 s38, s38, 1
  s_cbranch_scc1 L_end
  s_waitcnt lgkmcnt(0)
  v_readfirstlane_b32 s33, v20
  v_readfirstlane_b32 s49, v21
  v_readfirstlane_b32 s69, v22
  s_cmp_gt_u32 s33, s31
  s_cbranch_scc1 L_have_81
  s_sleep 1
  s_branch L_poll_82
L_have_81:
  v_add_u32 v20, s32, v249
  ds_read_b64_tr_b16 v[136:137], v20 offset:0
  ds_read_b64_tr_b16 v[138:139], v20 offset:512
  ds_read_b64_tr_b16 v[140:141], v20 offset:4096
  ds_read_b64_tr_b16 v[142:143], v20 offset:4608
  ds_read_b64_tr_b16 v[144:145], v20 offset:8192
  ds_read_b64_tr_b16 v[146:147], v20 offset:8704
  ds_read_b64_tr_b16 v[148:149], v20 offset:12288
  ds_read_b64_tr_b16 v[150:151], v20 offset:12800
  s_waitcnt lgkmcnt(0)
  s_add_u32 s31, s31, 1
  s_add_u32 s32, s32, 16384
  s_cmp_eq_u32 s32, 147456
  s_cselect_b32 s32, 0, s32
  v_mov_b32 v5, s31
  s_mov_b64 exec, 1
  ds_write_b32 v4, v5
  s_mov_b64 exec, -1
  s_cmp_gt_u32 s33, s31
  s_cbranch_scc1 L_have_83
L_poll_84:
  ds_read_b128 v[20:23], v3
  s_sub_u32 s38, s38, 1
  s_cbranch_scc1 L_end
  s_waitcnt lgkmcnt(0)
  v_readfirstlane_b32 s33, v20
  v_readfirstlane_b32 s49, v21
  v_readfirstlane_b32 s69, v22
  s_cmp_gt_u32 s33, s31
  s_cbranch_scc1 L_have_83
  s_sleep 1
  s_branch L_poll_84
L_have_83:
  v_add_u32 v20, s32, v249
  ds_read_b64_tr_b16 v[152:153], v20 offset:0
  ds_read_b64_tr_b16 v[154:155], v20 offset:512
  ds_read_b64_tr_b16 v[156:157], v20 offset:4096
  ds_read_b64_tr_b16 v[158:159], v20 offset:4608
  ds_read_b64_tr_b16 v[160:161], v20 offset:8192
  ds_read_b64_tr_b16 v[162:163], v20 offset:8704
  ds_read_b64_tr_b16 v[164:165], v20 offset:12288
  ds_read_b64_tr_b16 v[166:167], v20 offset:12800
  s_waitcnt lgkmcnt(0)
  s_add_u32 s31, s31, 1
  s_add_u32 s32, s32, 16384
  s_cmp_eq_u32 s32, 147456
  s_cselect_b32 s32, 0, s32
  v_mov_b32 v5, s31
  s_mov_b64 exec, 1
  ds_write_b32 v4, v5
  s_mov_b64 exec, -1
  s_cmp_gt_u32 s33, s31
  s_cbranch_scc1 L_have_85
L_poll_86:
  ds_read_b128 v[20:23], v3
  s_sub_u32 s38, s38, 1
  s_cbranch_scc1 L_end
  s_waitcnt lgkmcnt(0)
  v_readfirstlane_b32 s33, v20
  v_readfirstlane_b32 s49, v21
  v_readfirstlane_b32 s69, v22
  s_cmp_gt_u32 s33, s31
  s_cbranch_scc1 L_have_85
  s_sleep 1
  s_branch L_poll_86
L_have_85:
  v_add_u32 v20, s32, v249
  ds_read_b64_tr_b16 v[168:169], v20 offset:0
  ds_read_b64_tr_b16 v[170:171], v20 offset:512
  ds_read_b64_tr_b16 v[172:173], v20 offset:4096
  ds_read_b64_tr_b16 v[174:175], v20 offset:4608
  ds_read_b64_tr_b16 v[176:177], v20 offset:8192
  ds_read_b64_tr_b16 v[178:179], v20 offset:8704
  ds_read_b64_tr_b16 v[180:181], v20 offset:12288
  ds_read_b64_tr_b16 v[182:183], v20 offset:12800
  s_waitcnt lgkmcnt(0)
  s_add_u32 s31, s31, 1
  s_add_u32 s32, s32, 16384
  s_cmp_eq_u32 s32, 147456
  s_cselect_b32 s32, 0, s32
  v_mov_b32 v5, s31
  s_mov_b64 exec, 1
  ds_write_b32 v4, v5
  s_mov_b64 exec, -1
  s_cmp_gt_u32 s33, s31
  s_cbranch_scc1 L_have_87
L_poll_88:
  ds_read_b128 v[20:23], v3
  s_sub_u32 s38, s38, 1
  s_cbranch_scc1 L_end
  s_waitcnt lgkmcnt(0)
  v_readfirstlane_b32 s33, v20
  v_readfirstlane_b32 s49, v21
  v_readfirstlane_b32 s69, v22
  s_cmp_gt_u32 s33, s31
  s_cbranch_scc1 L_have_87
  s_sleep 1
  s_branch L_poll_88
L_have_87:
  v_add_u32 v20, s32, v249
  ds_read_b64_tr_b16 v[184:185], v20 offset:0
  ds_read_b64_tr_b16 v[186:187], v20 offset:512
  ds_read_b64_tr_b16 v[188:189], v20 offset:4096
  ds_read_b64_tr_b16 v[190:191], v20 offset:4608
  s_waitcnt lgkmcnt(0)
  s_add_u32 s31, s31, 1
  s_add_u32 s32, s32, 16384
  s_cmp_eq_u32 s32, 147456
  s_cselect_b32 s32, 0, s32
  v_mov_b32 v5, s31
  s_mov_b64 exec, 1
  ds_write_b32 v4, v5
  s_mov_b64 exec, -1
  s_cmp_gt_u32 s33, s31
  s_cbranch_scc1 L_have_89
L_poll_90:
  ds_read_b128 v[20:23], v3
  s_sub_u32 s38, s38, 1
  s_cbranch_scc1 L_end
  s_waitcnt lgkmcnt(0)
  v_readfirstlane_b32 s33, v20
  v_readfirstlane_b32 s49, v21
  v_readfirstlane_b32 s69, v22
  s_cmp_gt_u32 s33, s31
  s_cbranch_scc1 L_have_89
  s_sleep 1
  s_branch L_poll_90
L_have_89:
  v_add_u32 v20, s32, v248
  ds_read_b64_tr_b16 v[192:193], v20 offset:0
  ds_read_b64_tr_b16 v[196:197], v20 offset:32
  ds_read_b64_tr_b16 v[200:201], v20 offset:64
  ds_read_b64_tr_b16 v[204:205], v20 offset:96
  ds_read_b64_tr_b16 v[208:209], v20 offset:128
  ds_read_b64_tr_b16 v[212:213], v20 offset:160
  ds_read_b64_tr_b16 v[216:217], v20 offset:192
  s_waitcnt lgkmcnt(0)
  s_add_u32 s31, s31, 1
  s_add_u32 s32, s32, 16384
  s_cmp_eq_u32 s32, 147456
  s_cselect_b32 s32, 0, s32
  v_mov_b32 v5, s31
  s_mov_b64 exec, 1
  ds_write_b32 v4, v5
  s_mov_b64 exec, -1
  s_cmp_gt_u32 s33, s31
  s_cbranch_scc1 L_have_91
L_poll_92:
  ds_read_b128 v[20:23], v3
  s_sub_u32 s38, s38, 1
  s_cbranch_scc1 L_end
  s_waitcnt lgkmcnt(0)
  v_readfirstlane_b32 s33, v20
  v_readfirstlane_b32 s49, v21
  v_readfirstlane_b32 s69, v22
  s_cmp_gt_u32 s33, s31
  s_cbranch_scc1 L_have_91
  s_sleep 1
  s_branch L_poll_92
L_have_91:
  v_add_u32 v20, s32, v248
  ds_read_b64_tr_b16 v[194:195], v20 offset:0
  ds_read_b64_tr_b16 v[198:199], v20 offset:32
  ds_read_b64_tr_b16 v[202:203], v20 offset:64
  ds_read_b64_tr_b16 v[206:207], v20 offset:96
  ds_read_b64_tr_b16 v[210:211], v20 offset:128
  ds_read_b64_tr_b16 v[214:215], v20 offset:160
  ds_read_b64_tr_b16 v[218:219], v20 offset:192
  s_waitcnt lgkmcnt(0)
  s_add_u32 s31, s31, 1
  s_add_u32 s32, s32, 16384
  s_cmp_eq_u32 s32, 147456
  s_cselect_b32 s32, 0, s32
  v_mov_b32 v5, s31
  s_mov_b64 exec, 1
  ds_write_b32 v4, v5
  s_mov_b64 exec, -1
  s_cmp_gt_u32 s33, s31
  s_cbranch_scc1 L_have_93
L_poll_94:
  ds_read_b128 v[20:23], v3
  s_sub_u32 s38, s38, 1
  s_cbranch_scc1 L_end
  s_waitcnt lgkmcnt(0)
  v_readfirstlane_b32 s33, v20
  v_readfirstlane_b32 s49, v21
  v_readfirstlane_b32 s69, v22
  s_cmp_gt_u32 s33, s31
  s_cbranch_scc1 L_have_93
  s_sleep 1
  s_branch L_poll_94
L_have_93:
  v_add_u32 v20, s32, v248
  ds_read_b64_tr_b16 v[220:221], v20 offset:0
  ds_read_b64_tr_b16 v[224:225], v20 offset:32
  ds_read_b64_tr_b16 v[228:229], v20 offset:64
  ds_read_b64_tr_b16 v[232:233], v20 offset:96
  ds_read_b64_tr_b16 v[236:237], v20 offset:128
  ds_read_b64_tr_b16 v[240:241], v20 offset:160
  ds_read_b64_tr_b16 v[244:245], v20 offset:192
  s_waitcnt lgkmcnt(0)
  s_add_u32 s31, s31, 1
  s_add_u32 s32, s32, 16384
  s_cmp_eq_u32 s32, 147456
  s_cselect_b32 s32, 0, s32
  v_mov_b32 v5, s31
  s_mov_b64 exec, 1
  ds_write_b32 v4, v5
  s_mov_b64 exec, -1
  s_cmp_gt_u32 s33, s31
  s_cbranch_scc1 L_have_95
L_poll_96:
  ds_read_b128 v[20:23], v3
  s_sub_u32 s38, s38, 1
  s_cbranch_scc1 L_end
  s_waitcnt lgkmcnt(0)
  v_readfirstlane_b32 s33, v20
  v_readfirstlane_b32 s49, v21
  v_readfirstlane_b32 s69, v22
  s_cmp_gt_u32 s33, s31
  s_cbranch_scc1 L_have_95
  s_sleep 1
  s_branch L_poll_96
L_have_95:
  v_add_u32 v20, s32, v248
  ds_read_b64_tr_b16 v[222:223], v20 offset:0
  ds_read_b64_tr_b16 v[226:227], v20 offset:32
  ds_read_b64_tr_b16 v[230:231], v20 offset:64
  ds_read_b64_tr_b16 v[234:235], v20 offset:96
  ds_read_b64_tr_b16 v[238:239], v20 offset:128
  ds_read_b64_tr_b16 v[242:243], v20 offset:160
  ds_read_b64_tr_b16 v[246:247], v20 offset:192
  s_waitcnt lgkmcnt(0)
  s_add_u32 s31, s31, 1
  s_add_u32 s32, s32, 16384
  s_cmp_eq_u32 s32, 147456
  s_cselect_b32 s32, 0, s32
  v_mov_b32 v5, s31
  s_mov_b64 exec, 1
  ds_write_b32 v4, v5
  s_mov_b64 exec, -1
  s_branch L_ffn_w_done
L_ld_ffn:
  s_mov_b64 s[52:53], s[6:7]
  s_mov_b32 s54, 0
  s_mov_b32 s55, 0x20000
  v_lshrrev_b32 v1, 3, v0
  v_and_b32 v2, 7, v0
  v_and_b32 v3, 2, v1
  v_xor_b32 v2, v2, v3
  v_lshlrev_b32 v2, 4, v2
  v_mul_u32_u24 v3, 3584, v1
  v_add_u32 v17, v3, v2
  v_xor_b32 v2, 64, v2
  v_add_u32 v18, v3, v2
  v_lshlrev_b32 v16, 4, v0
  s_mov_b64 s[48:49], s[16:17]
  s_mov_b32 s50, 1605632
  s_lshl_b32 s61, s39, 7
  s_add_u32 s34, s33, 7
  s_cmp_ge_u32 s34, s31
  s_cbranch_scc1 L_free_97
L_freepoll_98:
  ds_read_b128 v[24:27], v21 offset:16
  s_sub_u32 s38, s38, 1
  s_cbranch_scc1 L_end
  s_waitcnt lgkmcnt(0)
  v_min3_u32 v24, v24, v25, v26
  v_min_u32 v24, v24, v27
  s_nop 0
  v_readfirstlane_b32 s33, v24
  s_add_u32 s34, s33, 7
  s_cmp_ge_u32 s34, s31
  s_cbranch_scc1 L_free_97
  s_sleep 1
  s_branch L_freepoll_98
L_free_97:
  s_mov_b32 m0, s32
  s_add_u32 s58, s61, 0
  buffer_load_dwordx4 v17, s[48:51], s58 offen nt lds
  s_add_u32 m0, s32, 1024
  s_add_u32 s58, s61, 28672
  buffer_load_dwordx4 v18, s[48:51], s58 offen nt lds
  s_add_u32 m0, s32, 2048
  s_add_u32 s58, s61, 57344
  buffer_load_dwordx4 v17, s[48:51], s58 offen nt lds
  s_add_u32 m0, s32, 3072
  s_add_u32 s58, s61, 86016
  buffer_load_dwordx4 v18, s[48:51], s58 offen nt lds
  s_waitcnt vmcnt(19)
  s_sub_u32 s34, s31, 1
  s_max_i32 s34, s34, s62
  v_mov_b32 v22, s34
  s_mov_b64 exec, 1
  ds_write_b32 v21, v22
  s_mov_b64 exec, -1
  s_add_u32 m0, s32, 4096
  s_add_u32 s58, s61, 114688
  buffer_load_dwordx4 v17, s[48:51], s58 offen nt lds
  s_add_u32 m0, s32, 5120
  s_add_u32 s58, s61, 143360
  buffer_load_dwordx4 v18, s[48:51], s58 offen nt lds
  s_add_u32 m0, s32, 6144
  s_add_u32 s58, s61, 172032
  buffer_load_dwordx4 v17, s[48:51], s58 offen nt lds
  s_add_u32 m0, s32, 7168
  s_add_u32 s58, s61, 200704
  buffer_load_dwordx4 v18, s[48:51], s58 offen nt lds
  s_waitcnt vmcnt(19)
  s_add_u32 m0, s32, 8192
  s_add_u32 s58, s61, 229376
  buffer_load_dwordx4 v17, s[48:51], s58 offen nt lds
  s_add_u32 m0, s32, 9216
  s_add_u32 s58, s61, 258048
  buffer_load_dwordx4 v18, s[48:51], s58 offen nt lds
  s_add_u32 m0, s32, 10240
  s_add_u32 s58, s61, 286720
  buffer_load_dwordx4 v17, s[48:51], s58 offen nt lds
  s_add_u32 m0, s32, 11264
  s_add_u32 s58, s61, 315392
  buffer_load_dwordx4 v18, s[48:51], s58 offen nt lds
  s_waitcnt vmcnt(19)
  s_add_u32 m0, s32, 12288
  s_add_u32 s58, s61, 344064
  buffer_load_dwordx4 v17, s[48:51], s58 offen nt lds
  s_add_u32 m0, s32, 13312
  s_add_u32 s58, s61, 372736
  buffer_load_dwordx4 v18, s[48:51], s58 offen nt lds
  s_add_u32 m0, s32, 14336
  s_add_u32 s58, s61, 401408
  buffer_load_dwordx4 v17, s[48:51], s58 offen nt lds
  s_add_u32 m0, s32, 15360
  s_add_u32 s58, s61, 430080
  buffer_load_dwordx4 v18, s[48:51], s58 offen nt lds
  s_waitcnt vmcnt(19)
  s_add_u32 s31, s31, 1
  s_add_u32 s32, s32, 16384
  s_cmp_eq_u32 s32, 147456
  s_cselect_b32 s32, 0, s32
  s_mov_b32 m0, s32
  s_add_u32 s58, s61, 458752
  buffer_load_dwordx4 v17, s[48:51], s58 offen nt lds
  s_add_u32 m0, s32, 1024
  s_add_u32 s58, s61, 487424
  buffer_load_dwordx4 v18, s[48:51], s58 offen nt lds
  s_add_u32 m0, s32, 2048
  s_add_u32 s58, s61, 516096
  buffer_load_dwordx4 v17, s[48:51], s58 offen nt lds
  s_add_u32 m0, s32, 3072
  s_add_u32 s58, s61, 544768
  buffer_load_dwordx4 v18, s[48:51], s58 offen nt lds
  s_waitcnt vmcnt(19)
  s_sub_u32 s34, s31, 1
  s_max_i32 s34, s34, s62
  v_mov_b32 v22, s34
  s_mov_b64 exec, 1
  ds_write_b32 v21, v22
  s_mov_b64 exec, -1
  s_add_u32 m0, s32, 4096
  s_add_u32 s58, s61, 573440
  buffer_load_dwordx4 v17, s[48:51], s58 offen nt lds
  s_add_u32 m0, s32, 5120
  s_add_u32 s58, s61, 602112
  buffer_load_dwordx4 v18, s[48:51], s58 offen nt lds
  s_add_u32 m0, s32, 6144
  s_add_u32 s58, s61, 630784
  buffer_load_dwordx4 v17, s[48:51], s58 offen nt lds
  s_add_u32 m0, s32, 7168
  s_add_u32 s58, s61, 659456
  buffer_load_dwordx4 v18, s[48:51], s58 offen nt lds
  s_waitcnt vmcnt(19)
  s_add_u32 m0, s32, 8192
  s_add_u32 s58, s61, 688128
  buffer_load_dwordx4 v17, s[48:51], s58 offen nt lds
  s_add_u32 m0, s32, 9216
  s_add_u32 s58, s61, 716800
  buffer_load_dwordx4 v18, s[48:51], s58 offen nt lds
  s_add_u32 m0, s32, 10240
  s_add_u32 s58, s61, 745472
  buffer_load_dwordx4 v17, s[48:51], s58 offen nt lds
  s_add_u32 m0, s32, 11264
  s_add_u32 s58, s61, 774144
  buffer_load_dwordx4 v18, s[48:51], s58 offen nt lds
  s_waitcnt vmcnt(19)
  s_add_u32 m0, s32, 12288
  s_add_u32 s58, s61, 802816
  buffer_load_dwordx4 v17, s[48:51], s58 offen nt lds
  s_add_u32 m0, s32, 13312
  s_add_u32 s58, s61, 831488
  buffer_load_dwordx4 v18, s[48:51], s58 offen nt lds
  s_add_u32 m0, s32, 14336
  s_add_u32 s58, s61, 860160
  buffer_load_dwordx4 v17, s[48:51], s58 offen nt lds
  s_add_u32 m0, s32, 15360
  s_add_u32 s58, s61, 888832
  buffer_load_dwordx4 v18, s[48:51], s58 offen nt lds
  s_waitcnt vmcnt(19)
  s_add_u32 s31, s31, 1
  s_add_u32 s32, s32, 16384
  s_cmp_eq_u32 s32, 147456
  s_cselect_b32 s32, 0, s32
  s_add_u32 s34, s33, 7
  s_cmp_ge_u32 s34, s31
  s_cbranch_scc1 L_free_99
L_freepoll_100:
  ds_read_b128 v[24:27], v21 offset:16
  s_sub_u32 s38, s38, 1
  s_cbranch_scc1 L_end
  s_waitcnt lgkmcnt(0)
  v_min3_u32 v24, v24, v25, v26
  v_min_u32 v24, v24, v27
  s_nop 0
  v_readfirstlane_b32 s33, v24
  s_add_u32 s34, s33, 7
  s_cmp_ge_u32 s34, s31
  s_cbranch_scc1 L_free_99
  s_sleep 1
  s_branch L_freepoll_100
L_free_99:
  s_mov_b32 m0, s32
  s_add_u32 s58, s61, 917504
  buffer_load_dwordx4 v17, s[48:51], s58 offen nt lds
  s_add_u32 m0, s32, 1024
  s_add_u32 s58, s61, 946176
  buffer_load_dwordx4 v18, s[48:51], s58 offen nt lds
  s_add_u32 m0, s32, 2048
  s_add_u32 s58, s61, 974848
  buffer_load_dwordx4 v17, s[48:51], s58 offen nt lds
  s_add_u32 m0, s32, 3072
  s_add_u32 s58, s61, 1003520
  buffer_load_dwordx4 v18, s[48:51], s58 offen nt lds
  s_waitcnt vmcnt(19)
  s_sub_u32 s34, s31, 1
  s_max_i32 s34, s34, s62
  v_mov_b32 v22, s34
  s_mov_b64 exec, 1
  ds_write_b32 v21, v22
  s_mov_b64 exec, -1
  s_add_u32 m0, s32, 4096
  s_add_u32 s58, s61, 1032192
  buffer_load_dwordx4 v17, s[48:51], s58 offen nt lds
  s_add_u32 m0, s32, 5120
  s_add_u32 s58, s61, 1060864
  buffer_load_dwordx4 v18, s[48:51], s58 offen nt lds
  s_add_u32 m0, s32, 6144
  s_add_u32 s58, s61, 1089536
  buffer_load_dwordx4 v17, s[48:51], s58 offen nt lds
  s_add_u32 m0, s32, 7168
  s_add_u32 s58, s61, 1118208
  buffer_load_dwordx4 v18, s[48:51], s58 offen nt lds
  s_waitcnt vmcnt(19)
  s_add_u32 m0, s32, 8192
  s_add_u32 s58, s61, 1146880
  buffer_load_dwordx4 v17, s[48:51], s58 offen nt lds
  s_add_u32 m0, s32, 9216
  s_add_u32 s58, s61, 1175552
  buffer_load_dwordx4 v18, s[48:51], s58 offen nt lds
  s_add_u32 m0, s32, 10240
  s_add_u32 s58, s61, 1204224
  buffer_load_dwordx4 v17, s[48:51], s58 offen nt lds
  s_add_u32 m0, s32, 11264
  s_add_u32 s58, s61, 1232896
  buffer_load_dwordx4 v18, s[48:51], s58 offen nt lds
  s_waitcnt vmcnt(19)
  s_add_u32 m0, s32, 12288
  s_add_u32 s58, s61, 1261568
  buffer_load_dwordx4 v17, s[48:51], s58 offen nt lds
  s_add_u32 m0, s32, 13312
  s_add_u32 s58, s61, 1290240
  buffer_load_dwordx4 v18, s[48:51], s58 offen nt lds
  s_add_u32 m0, s32, 14336
  s_add_u32 s58, s61, 1318912
  buffer_load_dwordx4 v17, s[48:51], s58 offen nt lds
  s_add_u32 m0, s32, 15360
  s_add_u32 s58, s61, 1347584
  buffer_load_dwordx4 v18, s[48:51], s58 offen nt lds
  s_waitcnt vmcnt(19)
  s_add_u32 s31, s31, 1
  s_add_u32 s32, s32, 16384
  s_cmp_eq_u32 s32, 147456
  s_cselect_b32 s32, 0, s32
  s_mov_b32 m0, s32
  s_add_u32 s58, s61, 1376256
  buffer_load_dwordx4 v17, s[48:51], s58 offen nt lds
  s_add_u32 m0, s32, 1024
  s_add_u32 s58, s61, 1404928
  buffer_load_dwordx4 v18, s[48:51], s58 offen nt lds
  s_add_u32 m0, s32, 2048
  s_add_u32 s58, s61, 1433600
  buffer_load_dwordx4 v17, s[48:51], s58 offen nt lds
  s_add_u32 m0, s32, 3072
  s_add_u32 s58, s61, 1462272
  buffer_load_dwordx4 v18, s[48:51], s58 offen nt lds
  s_waitcnt vmcnt(19)
  s_sub_u32 s34, s31, 1
  s_max_i32 s34, s34, s62
  v_mov_b32 v22, s34
  s_mov_b64 exec, 1
  ds_write_b32 v21, v22
  s_mov_b64 exec, -1
  s_add_u32 m0, s32, 4096
  s_add_u32 s58, s61, 1490944
  buffer_load_dwordx4 v17, s[48:51], s58 offen nt lds
  s_add_u32 m0, s32, 5120
  s_add_u32 s58, s61, 1519616
  buffer_load_dwordx4 v18, s[48:51], s58 offen nt lds
  s_add_u32 m0, s32, 6144
  s_add_u32 s58, s61, 1548288
  buffer_load_dwordx4 v17, s[48:51], s58 offen nt lds
  s_add_u32 m0, s32, 7168
  s_add_u32 s58, s61, 1576960
  buffer_load_dwordx4 v18, s[48:51], s58 offen nt lds
  s_waitcnt vmcnt(19)
  s_add_u32 m0, s32, 8192
  s_add_u32 s58, s61, 1605632
  buffer_load_dwordx4 v17, s[52:55], s58 offen nt lds
  s_add_u32 m0, s32, 9216
  s_add_u32 s58, s61, 1634304
  buffer_load_dwordx4 v18, s[52:55], s58 offen nt lds
  s_add_u32 m0, s32, 10240
  s_add_u32 s58, s61, 1662976
  buffer_load_dwordx4 v17, s[52:55], s58 offen nt lds
  s_add_u32 m0, s32, 11264
  s_add_u32 s58, s61, 1691648
  buffer_load_dwordx4 v18, s[52:55], s58 offen nt lds
  s_waitcnt vmcnt(19)
  s_add_u32 m0, s32, 12288
  s_add_u32 s58, s61, 1720320
  buffer_load_dwordx4 v17, s[52:55], s58 offen nt lds
  s_add_u32 m0, s32, 13312
  s_add_u32 s58, s61, 1748992
  buffer_load_dwordx4 v18, s[52:55], s58 offen nt lds
  s_add_u32 m0, s32, 14336
  s_add_u32 s58, s61, 1777664
  buffer_load_dwordx4 v17, s[52:55], s58 offen nt lds
  s_add_u32 m0, s32, 15360
  s_add_u32 s58, s61, 1806336
  buffer_load_dwordx4 v18, s[52:55], s58 offen nt lds
  s_waitcnt vmcnt(19)
  s_add_u32 s31, s31, 1
  s_add_u32 s32, s32, 16384
  s_cmp_eq_u32 s32, 147456
  s_cselect_b32 s32, 0, s32
  s_mov_b64 s[48:49], s[18:19]
  s_mul_i32 s61, s39, 57344
  s_add_u32 s36, s31, 4
L_ld_w2:
  s_add_u32 s34, s33, 8
  s_cmp_ge_u32 s34, s31
  s_cbranch_scc1 L_free_101
L_freepoll_102:
  ds_read_b128 v[24:27], v21 offset:16
  s_sub_u32 s38, s38, 1
  s_cbranch_scc1 L_end
  s_waitcnt lgkmcnt(0)
  v_min3_u32 v24, v24, v25, v26
  v_min_u32 v24, v24, v27
  s_nop 0
  v_readfirstlane_b32 s33, v24
  s_add_u32 s34, s33, 8
  s_cmp_ge_u32 s34, s31
  s_cbranch_scc1 L_free_101
  s_sleep 1
  s_branch L_freepoll_102
L_free_101:
  s_mov_b32 m0, s32
  s_mov_b32 s58, s61
  buffer_load_dwordx4 v16, s[48:51], s58 offen offset:0 nt lds
  buffer_load_dwordx4 v16, s[48:51], s58 offen offset:1024 nt lds
  buffer_load_dwordx4 v16, s[48:51], s58 offen offset:2048 nt lds
  buffer_load_dwordx4 v16, s[48:51], s58 offen offset:3072 nt lds
  s_waitcnt vmcnt(19)
  s_sub_u32 s34, s31, 1
  s_max_i32 s34, s34, s62
  v_mov_b32 v22, s34
  s_mov_b64 exec, 1
  ds_write_b32 v21, v22
  s_mov_b64 exec, -1
  s_add_u32 m0, s32, 4096
  s_add_u32 s58, s61, 4096
  buffer_load_dwordx4 v16, s[48:51], s58 offen offset:0 nt lds
  buffer_load_dwordx4 v16, s[48:51], s58 offen offset:1024 nt lds
  buffer_load_dwordx4 v16, s[48:51], s58 offen offset:2048 nt lds
  buffer_load_dwordx4 v16, s[48:51], s58 offen offset:3072 nt lds
  s_waitcnt vmcnt(19)
  s_add_u32 m0, s32, 8192
  s_add_u32 s58, s61, 8192
  buffer_load_dwordx4 v16, s[48:51], s58 offen offset:0 nt lds
  buffer_load_dwordx4 v16, s[48:51], s58 offen offset:1024 nt lds
  buffer_load_dwordx4 v16, s[48:51], s58 offen offset:2048 nt lds
  buffer_load_dwordx4 v16, s[48:51], s58 offen offset:3072 nt lds
  s_waitcnt vmcnt(19)
  s_add_u32 m0, s32, 12288
  s_add_u32 s58, s61, 12288
  buffer_load_dwordx4 v16, s[48:51], s58 offen offset:0 nt lds
  buffer_load_dwordx4 v16, s[48:51], s58 offen offset:1024 nt lds
  buffer_load_dwordx4 v16, s[52:55], s58 offen offset:2048 nt lds
  buffer_load_dwordx4 v16, s[52:55], s58 offen offset:3072 nt lds
  s_waitcnt vmcnt(19)
  s_add_u32 s31, s31, 1
  s_add_u32 s32, s32, 16384
  s_cmp_eq_u32 s32, 147456
  s_cselect_b32 s32, 0, s32
  s_add_u32 s61, s61, 14336
  s_cmp_lt_u32 s31, s36
  s_cbranch_scc1 L_ld_w2
  s_branch L_ld_head_done
L_probe:
  s_load_dword s69, s[24:25], 0
  v_and_b32 v32, 1, v0
  v_lshlrev_b32 v32, 13, v32
  v_lshrrev_b32 v33, 2, v0
  v_lshl_add_u32 v32, v33, 8, v32
  v_bfe_u32 v33, v0, 1, 1
  v_mul_u32_u24 v33, 2031616, v33
  v_add_u32 v32, v32, v33
  v_add_u32 v32, 65536, v32
  v_mov_b32 v36, 0
  s_mov_b32 s37, 3
  s_mov_b64 exec, 0xfff
  global_atomic_add v37, v32, v36, s[24:25] sc0
  s_mov_b64 exec, 1
  v_mov_b32 v32, 65536
  s_mov_b32 s92, -1
  v_mov_b32 v33, 73728
  s_mov_b32 s93, -1
  v_mov_b32 v34, 2097152
  s_mov_b32 s94, -1
  v_mov_b32 v35, 2105344
  s_mov_b32 s95, -1
  s_waitcnt vmcnt(0)
L_probe_loop:
  s_memtime s[64:65]
  s_waitcnt lgkmcnt(0)
  global_atomic_add v37, v32, v36, s[24:25] sc0
  s_waitcnt vmcnt(0)
  s_memtime s[66:67]
  v_add_u32 v32, 256, v32
  s_waitcnt lgkmcnt(0)
  s_sub_u32 s66, s66, s64
  s_min_u32 s92, s92, s66
  s_memtime s[64:65]
  s_waitcnt lgkmcnt(0)
  global_atomic_add v37, v33, v36, s[24:25] sc0
  s_waitcnt vmcnt(0)
  s_memtime s[66:67]
  v_add_u32 v33, 256, v33
  s_waitcnt lgkmcnt(0)
  s_sub_u32 s66, s66, s64
  s_min_u32 s93, s93, s66
  s_memtime s[64:65]
  s_waitcnt lgkmcnt(0)
  global_atomic_add v37, v34, v36, s[24:25] sc0
  s_waitcnt vmcnt(0)
  s_memtime s[66:67]
  v_add_u32 v34, 256, v34
  s_waitcnt lgkmcnt(0)
  s_sub_u32 s66, s66, s64
  s_min_u32 s94, s94, s66
  s_memtime s[64:65]
  s_waitcnt lgkmcnt(0)
  global_atomic_add v37, v35, v36, s[24:25] sc0
  s_waitcnt vmcnt(0)
  s_memtime s[66:67]
  v_add_u32 v35, 256, v35
  s_waitcnt lgkmcnt(0)
  s_sub_u32 s66, s66, s64
  s_min_u32 s95, s95, s66
  s_sub_u32 s37, s37, 1
  s_cmp_lg_u32 s37, 0
  s_cbranch_scc1 L_probe_loop
  s_cmp_gt_u32 s92, s93
  s_cselect_b32 s34, 8192, 0
  s_cmp_gt_u32 s94, s95
  s_cselect_b32 s35, 8192, 0
  s_mul_i32 s36, s69, 0x9e3779b1
  s_add_u32 s36, s36, 0x7f4a7c15
  v_mov_b32 v32, s34
  v_mov_b32 v33, s36
  v_mov_b32 v34, s35
  v_mov_b32 v35, s36
  v_mov_b32 v36, 2048
  global_store_dwordx4 v36, v[32:35], s[24:25] sc1
  s_mov_b64 exec, -1
  s_branch L_ld_wo
.section .rodata,"a"
.p2align 6
.amdhsa_kernel sequential_preLN__gqa_block_cached__dense_activation_silu__decode_kernel
  .amdhsa_next_free_vgpr 256
  .amdhsa_next_free_sgpr 102
  .amdhsa_accum_offset 256
  .amdhsa_group_segment_fixed_size 0
  .amdhsa_kernarg_size 88
  .amdhsa_user_sgpr_count 2
  .amdhsa_user_sgpr_kernarg_segment_ptr 1
  .amdhsa_system_sgpr_workgroup_id_x 1
.end_amdhsa_kernel
```
